```python
import torch

def _softmax(x, axis=-1):
    return torch.softmax(x, dim=axis)
def _gelu(x):
    return torch.nn.functional.gelu(x, approximate="tanh")
def _silu(x):
    return torch.nn.functional.silu(x)
def _sigmoid(x):
    return torch.sigmoid(x)
def _layernorm(x, axis=-1, eps=1e-5):
    m = x.mean(dim=axis, keepdim=True)
    v = x.var(dim=axis, keepdim=True, unbiased=False)
    return (x - m) / torch.sqrt(v + eps)
def _scatter_add(tgt, idx, src, axis=0):
    return tgt.clone().index_add_(axis, idx, src)
def _segment_sum(src, seg, n):
    out = torch.zeros((n,) + src.shape[1:], dtype=src.dtype)
    return out.index_add_(0, seg, src)
def _pad(x, pw):
    flat = tuple(v for pair in reversed(pw) for v in pair)
    return torch.nn.functional.pad(x, flat)

kernel_name = 'standalone__self_sup_conv_stem_hubert__speech'

def setup_inputs():

    _w = (lambda a: (lambda t: t.to(torch.bfloat16) if t.is_floating_point() else t)(torch.as_tensor(a)))
    B, T, D, K = 2, 4000, 512, 3
    scale = (1.0 / (K * D)) ** 0.5
    return {
        "x": _w((lambda *s: torch.randn(*s, dtype=torch.bfloat16) * 0.05)(B, T, D)),
        "w": _w((lambda *s: torch.randn(*s, dtype=torch.bfloat16) * 0.05)(K, D, D) * scale),
        "b": _w((lambda *s: torch.randn(*s, dtype=torch.bfloat16) * 0.05)(D) * 0.1),
        "gamma": _w(torch.ones((D,), dtype=float)),
        "beta": _w(torch.zeros((D,), dtype=float)),
    }

def reference(x, w, b, gamma, beta):
    B, T, D = x.shape
    K = w.shape[0]
    s = 2
    L = (T - K) // s + 1
    y = torch.einsum('blc,cd->bld', x[:, 0 : s * L : s, :], w[0])
    for i in range(1, K):
        y = y + torch.einsum('blc,cd->bld', x[:, i : i + s * L : s, :], w[i])
    y = y + b[None, None, :]
    mu = y.mean(1, keepdims=True)
    var = ((y - mu) ** 2).mean(1, keepdims=True)
    yn = (y - mu) / torch.sqrt(var + 1e-5)
    yn = yn * gamma[None, None, :] + beta[None, None, :]
    return _gelu(yn)
```

```asm
; @launch kernel=conv_gemm_kernel grid=(256,1,1) block=(256,1,1) lds=142336
; @launch kernel=norm_gelu_kernel grid=(256,1,1) block=(256,1,1) lds=512
.amdgcn_target "amdgcn-amd-amdhsa--gfx950"
.text
.globl conv_gemm_kernel
.p2align 8
.type conv_gemm_kernel,@function
conv_gemm_kernel:
    s_cmp_ge_u32 s2, 256
    s_cbranch_scc1 L_g_done
    s_load_dwordx4 s[4:7], s[0:1], 0
    s_load_dwordx2 s[8:9], s[0:1], 16
    s_load_dwordx2 s[10:11], s[0:1], 56
    s_and_b32 s34, s2, 7
    s_lshr_b32 s35, s2, 3
    s_lshl_b32 s34, s34, 2
    s_lshr_b32 s29, s35, 3
    s_add_u32 s29, s29, s34
    s_and_b32 s30, s35, 7
    s_lshr_b32 s28, s29, 4
    s_and_b32 s29, s29, 15
    s_lshl_b32 s32, s30, 6
    s_lshl_b32 s33, s29, 7
    v_and_b32 v1, 63, v0
    v_lshrrev_b32 v2, 6, v0
    s_nop 0
    v_readfirstlane_b32 s31, v2
    s_waitcnt lgkmcnt(0)
    s_mov_b32 s12, s4
    s_and_b32 s13, s5, 0xffff
    s_mov_b32 s14, 8192000
    s_mov_b32 s15, 0x00020000
    s_mov_b32 s16, s6
    s_and_b32 s17, s7, 0xffff
    s_mov_b32 s18, 1572864
    s_mov_b32 s19, 0x00020000
    s_mov_b32 s20, s10
    s_and_b32 s21, s11, 0xffff
    s_mov_b32 s22, 4325376
    s_mov_b32 s23, 0x00020000
    s_mov_b32 s24, s8
    s_and_b32 s25, s9, 0xffff
    s_mov_b32 s26, 1024
    s_mov_b32 s27, 0x00020000
    s_lshl_b32 s34, s31, 5
    s_add_u32 s34, s34, s33
    v_and_b32 v8, 31, v1
    v_lshrrev_b32 v9, 3, v1
    v_add_u32 v9, s34, v9
    v_lshlrev_b32 v9, 1, v9
    s_mul_i32 s35, s28, 4000
    v_add_u32 v9, s35, v9
    v_lshlrev_b32 v9, 10, v9
    v_and_b32 v10, 7, v1
    v_lshrrev_b32 v11, 4, v1
    v_xor_b32 v10, v10, v11
    v_xor_b32 v11, 4, v10
    v_lshlrev_b32 v10, 4, v10
    v_lshlrev_b32 v11, 4, v11
    v_add_u32 v2, v9, v10
    v_add_u32 v16, v9, v11
    v_lshrrev_b32 v10, 5, v1
    s_lshl_b32 s35, s31, 5
    v_add_u32 v12, s35, v8
    v_bfe_u32 v11, v12, 1, 3
    v_lshlrev_b32 v12, 7, v12
    v_add_u32 v13, 0, v10
    v_xor_b32 v13, v13, v11
    v_lshlrev_b32 v13, 4, v13
    v_add_u32 v17, v12, v13
    v_add_u32 v13, 2, v10
    v_xor_b32 v13, v13, v11
    v_lshlrev_b32 v13, 4, v13
    v_add_u32 v18, v12, v13
    v_add_u32 v13, 4, v10
    v_xor_b32 v13, v13, v11
    v_lshlrev_b32 v13, 4, v13
    v_add_u32 v19, v12, v13
    v_add_u32 v13, 6, v10
    v_xor_b32 v13, v13, v11
    v_lshlrev_b32 v13, 4, v13
    v_add_u32 v20, v12, v13
    v_add_u32 v12, s35, v8
    v_add_u32 v12, 1, v12
    v_bfe_u32 v11, v12, 1, 3
    v_lshlrev_b32 v12, 7, v12
    v_add_u32 v13, 0, v10
    v_xor_b32 v13, v13, v11
    v_lshlrev_b32 v13, 4, v13
    v_add_u32 v21, v12, v13
    v_add_u32 v13, 2, v10
    v_xor_b32 v13, v13, v11
    v_lshlrev_b32 v13, 4, v13
    v_add_u32 v22, v12, v13
    v_add_u32 v13, 4, v10
    v_xor_b32 v13, v13, v11
    v_lshlrev_b32 v13, 4, v13
    v_add_u32 v23, v12, v13
    v_add_u32 v13, 6, v10
    v_xor_b32 v13, v13, v11
    v_lshlrev_b32 v13, 4, v13
    v_add_u32 v24, v12, v13
    s_lshl_b32 s56, s31, 16
    s_sub_u32 s56, 262144, s56
    v_lshrrev_b32 v9, 3, v1
    s_lshl_b32 s35, s31, 4
    v_add_u32 v9, s35, v9
    v_lshlrev_b32 v9, 10, v9
    v_and_b32 v10, 7, v1
    v_lshrrev_b32 v11, 4, v1
    v_and_b32 v11, 1, v11
    v_lshlrev_b32 v11, 2, v11
    v_xor_b32 v10, v10, v11
    v_lshlrev_b32 v10, 4, v10
    v_add_u32 v9, v9, v10
    s_lshl_b32 s35, s32, 1
    v_add_u32 v3, s35, v9
    v_lshrrev_b32 v9, 5, v1
    v_lshlrev_b32 v9, 3, v9
    v_bfe_u32 v10, v1, 2, 2
    v_add_u32 v9, v9, v10
    v_lshlrev_b32 v9, 7, v9
    v_bfe_u32 v11, v1, 4, 1
    v_lshlrev_b32 v11, 1, v11
    v_bfe_u32 v12, v1, 1, 1
    v_add_u32 v11, v11, v12
    v_bfe_u32 v12, v1, 3, 1
    v_lshlrev_b32 v12, 2, v12
    v_add_u32 v13, v11, v12
    v_xor_b32 v12, 4, v12
    v_add_u32 v14, v11, v12
    v_and_b32 v15, 1, v1
    v_lshlrev_b32 v15, 3, v15
    v_add_u32 v9, v9, v15
    v_lshlrev_b32 v13, 4, v13
    v_lshlrev_b32 v14, 4, v14
    v_add_u32 v4, v9, v13
    v_add_u32 v5, v9, v14
    v_lshlrev_b32 v9, 1, v8
    s_lshl_b32 s35, s32, 1
    v_add_u32 v9, s35, v9
    buffer_load_ushort v6, v9, s[24:27], 0 offen
    buffer_load_ushort v7, v9, s[24:27], 0 offen offset:64
    v_mov_b32 v32, 0
    v_mov_b32 v33, 0
    v_mov_b32 v34, 0
    v_mov_b32 v35, 0
    v_mov_b32 v36, 0
    v_mov_b32 v37, 0
    v_mov_b32 v38, 0
    v_mov_b32 v39, 0
    v_mov_b32 v40, 0
    v_mov_b32 v41, 0
    v_mov_b32 v42, 0
    v_mov_b32 v43, 0
    v_mov_b32 v44, 0
    v_mov_b32 v45, 0
    v_mov_b32 v46, 0
    v_mov_b32 v47, 0
    v_mov_b32 v48, 0
    v_mov_b32 v49, 0
    v_mov_b32 v50, 0
    v_mov_b32 v51, 0
    v_mov_b32 v52, 0
    v_mov_b32 v53, 0
    v_mov_b32 v54, 0
    v_mov_b32 v55, 0
    v_mov_b32 v56, 0
    v_mov_b32 v57, 0
    v_mov_b32 v58, 0
    v_mov_b32 v59, 0
    v_mov_b32 v60, 0
    v_mov_b32 v61, 0
    v_mov_b32 v62, 0
    v_mov_b32 v63, 0
    s_lshl_b32 s39, s31, 11
    s_lshl_b32 s47, s31, 12
    s_add_u32 s40, s47, 40960
    s_mov_b32 m0, s40
    s_mov_b32 s42, 0
    buffer_load_dwordx4 v2, s[12:15], s42 offen lds
    s_add_u32 s40, s47, 41984
    s_mov_b32 m0, s40
    s_mov_b32 s42, 16384
    buffer_load_dwordx4 v16, s[12:15], s42 offen lds
    s_add_u32 s40, s47, 43008
    s_mov_b32 m0, s40
    s_mov_b32 s42, 32768
    buffer_load_dwordx4 v2, s[12:15], s42 offen lds
    s_add_u32 s40, s47, 44032
    s_mov_b32 m0, s40
    s_mov_b32 s42, 49152
    buffer_load_dwordx4 v16, s[12:15], s42 offen lds
    s_add_u32 s40, s47, 58368
    s_mov_b32 m0, s40
    s_mov_b32 s42, 1024
    buffer_load_dwordx4 v2, s[12:15], s42 offen lds
    s_add_u32 s40, s47, 59392
    s_mov_b32 m0, s40
    s_mov_b32 s42, 17408
    buffer_load_dwordx4 v16, s[12:15], s42 offen lds
    s_add_u32 s40, s47, 60416
    s_mov_b32 m0, s40
    s_mov_b32 s42, 33792
    buffer_load_dwordx4 v2, s[12:15], s42 offen lds
    s_add_u32 s40, s47, 61440
    s_mov_b32 m0, s40
    s_mov_b32 s42, 50176
    buffer_load_dwordx4 v16, s[12:15], s42 offen lds
    s_mov_b32 m0, 57344
    s_add_u32 s42, s56, 0
    buffer_load_dwordx4 v2, s[12:15], s42 offen lds
    s_add_u32 s40, s39, 0
    s_mov_b32 m0, s40
    s_mov_b32 s41, 0
    buffer_load_dwordx4 v3, s[16:19], s41 offen lds
    s_add_u32 s40, s39, 1024
    s_mov_b32 m0, s40
    s_mov_b32 s41, 8192
    buffer_load_dwordx4 v3, s[16:19], s41 offen lds
    s_add_u32 s40, s39, 8192
    s_mov_b32 m0, s40
    s_mov_b32 s41, 524288
    buffer_load_dwordx4 v3, s[16:19], s41 offen lds
    s_add_u32 s40, s39, 9216
    s_mov_b32 m0, s40
    s_mov_b32 s41, 532480
    buffer_load_dwordx4 v3, s[16:19], s41 offen lds
    s_add_u32 s40, s47, 74752
    s_mov_b32 m0, s40
    s_mov_b32 s42, 128
    buffer_load_dwordx4 v2, s[12:15], s42 offen lds
    s_add_u32 s40, s47, 75776
    s_mov_b32 m0, s40
    s_mov_b32 s42, 16512
    buffer_load_dwordx4 v16, s[12:15], s42 offen lds
    s_add_u32 s40, s47, 76800
    s_mov_b32 m0, s40
    s_mov_b32 s42, 32896
    buffer_load_dwordx4 v2, s[12:15], s42 offen lds
    s_add_u32 s40, s47, 77824
    s_mov_b32 m0, s40
    s_mov_b32 s42, 49280
    buffer_load_dwordx4 v16, s[12:15], s42 offen lds
    s_add_u32 s40, s47, 92160
    s_mov_b32 m0, s40
    s_mov_b32 s42, 1152
    buffer_load_dwordx4 v2, s[12:15], s42 offen lds
    s_add_u32 s40, s47, 93184
    s_mov_b32 m0, s40
    s_mov_b32 s42, 17536
    buffer_load_dwordx4 v16, s[12:15], s42 offen lds
    s_add_u32 s40, s47, 94208
    s_mov_b32 m0, s40
    s_mov_b32 s42, 33920
    buffer_load_dwordx4 v2, s[12:15], s42 offen lds
    s_add_u32 s40, s47, 95232
    s_mov_b32 m0, s40
    s_mov_b32 s42, 50304
    buffer_load_dwordx4 v16, s[12:15], s42 offen lds
    s_mov_b32 m0, 91136
    s_add_u32 s42, s56, 128
    buffer_load_dwordx4 v2, s[12:15], s42 offen lds
    s_add_u32 s40, s39, 16384
    s_mov_b32 m0, s40
    s_mov_b32 s41, 1048576
    buffer_load_dwordx4 v3, s[16:19], s41 offen lds
    s_add_u32 s40, s39, 17408
    s_mov_b32 m0, s40
    s_mov_b32 s41, 1056768
    buffer_load_dwordx4 v3, s[16:19], s41 offen lds
    s_add_u32 s40, s39, 24576
    s_mov_b32 m0, s40
    s_mov_b32 s41, 65536
    buffer_load_dwordx4 v3, s[16:19], s41 offen lds
    s_add_u32 s40, s39, 25600
    s_mov_b32 m0, s40
    s_mov_b32 s41, 73728
    buffer_load_dwordx4 v3, s[16:19], s41 offen lds
    s_add_u32 s40, s39, 32768
    s_mov_b32 m0, s40
    s_mov_b32 s41, 589824
    buffer_load_dwordx4 v3, s[16:19], s41 offen lds
    s_add_u32 s40, s39, 33792
    s_mov_b32 m0, s40
    s_mov_b32 s41, 598016
    buffer_load_dwordx4 v3, s[16:19], s41 offen lds
    s_waitcnt vmcnt(17)
    s_barrier
    v_add_u32 v25, 40960, v17
    ds_read_b128 v[64:67], v25
    ds_read_b64_tr_b16 v[128:129], v4 offset:0
    ds_read_b64_tr_b16 v[130:131], v4 offset:512
    ds_read_b64_tr_b16 v[132:133], v5 offset:0
    ds_read_b64_tr_b16 v[134:135], v5 offset:512
    v_add_u32 v25, 40960, v18
    ds_read_b128 v[68:71], v25
    ds_read_b64_tr_b16 v[136:137], v4 offset:2048
    ds_read_b64_tr_b16 v[138:139], v4 offset:2560
    ds_read_b64_tr_b16 v[140:141], v5 offset:2048
    ds_read_b64_tr_b16 v[142:143], v5 offset:2560
    v_add_u32 v25, 40960, v19
    ds_read_b128 v[72:75], v25
    ds_read_b64_tr_b16 v[144:145], v4 offset:4096
    ds_read_b64_tr_b16 v[146:147], v4 offset:4608
    ds_read_b64_tr_b16 v[148:149], v5 offset:4096
    ds_read_b64_tr_b16 v[150:151], v5 offset:4608
    v_add_u32 v25, 40960, v20
    ds_read_b128 v[76:79], v25
    ds_read_b64_tr_b16 v[152:153], v4 offset:6144
    ds_read_b64_tr_b16 v[154:155], v4 offset:6656
    ds_read_b64_tr_b16 v[156:157], v5 offset:6144
    ds_read_b64_tr_b16 v[158:159], v5 offset:6656
    s_waitcnt vmcnt(15) lgkmcnt(0)
    s_barrier
    s_add_u32 s40, s39, 0
    s_mov_b32 m0, s40
    s_mov_b32 s41, 1114112
    buffer_load_dwordx4 v3, s[16:19], s41 offen lds
    s_add_u32 s40, s39, 1024
    s_mov_b32 m0, s40
    s_mov_b32 s41, 1122304
    buffer_load_dwordx4 v3, s[16:19], s41 offen lds
    s_add_u32 s40, s47, 108544
    s_mov_b32 m0, s40
    s_mov_b32 s42, 256
    buffer_load_dwordx4 v2, s[12:15], s42 offen lds
    s_add_u32 s40, s47, 109568
    s_mov_b32 m0, s40
    s_mov_b32 s42, 16640
    buffer_load_dwordx4 v16, s[12:15], s42 offen lds
    s_add_u32 s40, s47, 110592
    s_mov_b32 m0, s40
    s_mov_b32 s42, 33024
    buffer_load_dwordx4 v2, s[12:15], s42 offen lds
    s_add_u32 s40, s47, 111616
    s_mov_b32 m0, s40
    s_mov_b32 s42, 49408
    buffer_load_dwordx4 v16, s[12:15], s42 offen lds
    v_mfma_f32_32x32x16_bf16 v[32:47], v[64:67], v[128:131], v[32:47]
    v_add_u32 v25, 58368, v17
    ds_read_b128 v[80:83], v25
    ds_read_b64_tr_b16 v[160:161], v4 offset:8192
    ds_read_b64_tr_b16 v[162:163], v4 offset:8704
    v_mfma_f32_32x32x16_bf16 v[48:63], v[64:67], v[132:135], v[48:63]
    ds_read_b64_tr_b16 v[164:165], v5 offset:8192
    ds_read_b64_tr_b16 v[166:167], v5 offset:8704
    v_mfma_f32_32x32x16_bf16 v[32:47], v[68:71], v[136:139], v[32:47]
    v_add_u32 v25, 58368, v18
    ds_read_b128 v[84:87], v25
    ds_read_b64_tr_b16 v[168:169], v4 offset:10240
    ds_read_b64_tr_b16 v[170:171], v4 offset:10752
    v_mfma_f32_32x32x16_bf16 v[48:63], v[68:71], v[140:143], v[48:63]
    ds_read_b64_tr_b16 v[172:173], v5 offset:10240
    ds_read_b64_tr_b16 v[174:175], v5 offset:10752
    v_mfma_f32_32x32x16_bf16 v[32:47], v[72:75], v[144:147], v[32:47]
    v_add_u32 v25, 58368, v19
    ds_read_b128 v[88:91], v25
    ds_read_b64_tr_b16 v[176:177], v4 offset:12288
    ds_read_b64_tr_b16 v[178:179], v4 offset:12800
    v_mfma_f32_32x32x16_bf16 v[48:63], v[72:75], v[148:151], v[48:63]
    ds_read_b64_tr_b16 v[180:181], v5 offset:12288
    ds_read_b64_tr_b16 v[182:183], v5 offset:12800
    v_mfma_f32_32x32x16_bf16 v[32:47], v[76:79], v[152:155], v[32:47]
    v_add_u32 v25, 58368, v20
    ds_read_b128 v[92:95], v25
    ds_read_b64_tr_b16 v[184:185], v4 offset:14336
    ds_read_b64_tr_b16 v[186:187], v4 offset:14848
    v_mfma_f32_32x32x16_bf16 v[48:63], v[76:79], v[156:159], v[48:63]
    ds_read_b64_tr_b16 v[188:189], v5 offset:14336
    ds_read_b64_tr_b16 v[190:191], v5 offset:14848
    s_waitcnt vmcnt(10) lgkmcnt(0)
    s_barrier
    s_add_u32 s40, s39, 8192
    s_mov_b32 m0, s40
    s_mov_b32 s41, 131072
    buffer_load_dwordx4 v3, s[16:19], s41 offen lds
    s_add_u32 s40, s39, 9216
    s_mov_b32 m0, s40
    s_mov_b32 s41, 139264
    buffer_load_dwordx4 v3, s[16:19], s41 offen lds
    s_add_u32 s40, s47, 125952
    s_mov_b32 m0, s40
    s_mov_b32 s42, 1280
    buffer_load_dwordx4 v2, s[12:15], s42 offen lds
    s_add_u32 s40, s47, 126976
    s_mov_b32 m0, s40
    s_mov_b32 s42, 17664
    buffer_load_dwordx4 v16, s[12:15], s42 offen lds
    s_add_u32 s40, s47, 128000
    s_mov_b32 m0, s40
    s_mov_b32 s42, 34048
    buffer_load_dwordx4 v2, s[12:15], s42 offen lds
    s_add_u32 s40, s47, 129024
    s_mov_b32 m0, s40
    s_mov_b32 s42, 50432
    buffer_load_dwordx4 v16, s[12:15], s42 offen lds
    v_mfma_f32_32x32x16_bf16 v[32:47], v[80:83], v[160:163], v[32:47]
    v_add_u32 v25, 40960, v21
    ds_read_b128 v[64:67], v25
    ds_read_b64_tr_b16 v[128:129], v4 offset:16384
    ds_read_b64_tr_b16 v[130:131], v4 offset:16896
    v_mfma_f32_32x32x16_bf16 v[48:63], v[80:83], v[164:167], v[48:63]
    ds_read_b64_tr_b16 v[132:133], v5 offset:16384
    ds_read_b64_tr_b16 v[134:135], v5 offset:16896
    v_mfma_f32_32x32x16_bf16 v[32:47], v[84:87], v[168:171], v[32:47]
    v_add_u32 v25, 40960, v22
    ds_read_b128 v[68:71], v25
    ds_read_b64_tr_b16 v[136:137], v4 offset:18432
    ds_read_b64_tr_b16 v[138:139], v4 offset:18944
    v_mfma_f32_32x32x16_bf16 v[48:63], v[84:87], v[172:175], v[48:63]
    ds_read_b64_tr_b16 v[140:141], v5 offset:18432
    ds_read_b64_tr_b16 v[142:143], v5 offset:18944
    v_mfma_f32_32x32x16_bf16 v[32:47], v[88:91], v[176:179], v[32:47]
    v_add_u32 v25, 40960, v23
    ds_read_b128 v[72:75], v25
    ds_read_b64_tr_b16 v[144:145], v4 offset:20480
    ds_read_b64_tr_b16 v[146:147], v4 offset:20992
    v_mfma_f32_32x32x16_bf16 v[48:63], v[88:91], v[180:183], v[48:63]
    ds_read_b64_tr_b16 v[148:149], v5 offset:20480
    ds_read_b64_tr_b16 v[150:151], v5 offset:20992
    v_mfma_f32_32x32x16_bf16 v[32:47], v[92:95], v[184:187], v[32:47]
    v_add_u32 v25, 40960, v24
    ds_read_b128 v[76:79], v25
    ds_read_b64_tr_b16 v[152:153], v4 offset:22528
    ds_read_b64_tr_b16 v[154:155], v4 offset:23040
    v_mfma_f32_32x32x16_bf16 v[48:63], v[92:95], v[188:191], v[48:63]
    ds_read_b64_tr_b16 v[156:157], v5 offset:22528
    ds_read_b64_tr_b16 v[158:159], v5 offset:23040
    s_waitcnt vmcnt(14) lgkmcnt(0)
    s_barrier
    s_add_u32 s40, s39, 16384
    s_mov_b32 m0, s40
    s_mov_b32 s41, 655360
    buffer_load_dwordx4 v3, s[16:19], s41 offen lds
    s_add_u32 s40, s39, 17408
    s_mov_b32 m0, s40
    s_mov_b32 s41, 663552
    buffer_load_dwordx4 v3, s[16:19], s41 offen lds
    s_mov_b32 m0, 124928
    s_add_u32 s42, s56, 256
    buffer_load_dwordx4 v2, s[12:15], s42 offen lds
    v_mfma_f32_32x32x16_bf16 v[32:47], v[64:67], v[128:131], v[32:47]
    v_add_u32 v25, 74752, v17
    ds_read_b128 v[80:83], v25
    ds_read_b64_tr_b16 v[160:161], v4 offset:24576
    ds_read_b64_tr_b16 v[162:163], v4 offset:25088
    v_mfma_f32_32x32x16_bf16 v[48:63], v[64:67], v[132:135], v[48:63]
    ds_read_b64_tr_b16 v[164:165], v5 offset:24576
    ds_read_b64_tr_b16 v[166:167], v5 offset:25088
    v_mfma_f32_32x32x16_bf16 v[32:47], v[68:71], v[136:139], v[32:47]
    v_add_u32 v25, 74752, v18
    ds_read_b128 v[84:87], v25
    ds_read_b64_tr_b16 v[168:169], v4 offset:26624
    ds_read_b64_tr_b16 v[170:171], v4 offset:27136
    v_mfma_f32_32x32x16_bf16 v[48:63], v[68:71], v[140:143], v[48:63]
    ds_read_b64_tr_b16 v[172:173], v5 offset:26624
    ds_read_b64_tr_b16 v[174:175], v5 offset:27136
    v_mfma_f32_32x32x16_bf16 v[32:47], v[72:75], v[144:147], v[32:47]
    v_add_u32 v25, 74752, v19
    ds_read_b128 v[88:91], v25
    ds_read_b64_tr_b16 v[176:177], v4 offset:28672
    ds_read_b64_tr_b16 v[178:179], v4 offset:29184
    v_mfma_f32_32x32x16_bf16 v[48:63], v[72:75], v[148:151], v[48:63]
    ds_read_b64_tr_b16 v[180:181], v5 offset:28672
    ds_read_b64_tr_b16 v[182:183], v5 offset:29184
    v_mfma_f32_32x32x16_bf16 v[32:47], v[76:79], v[152:155], v[32:47]
    v_add_u32 v25, 74752, v20
    ds_read_b128 v[92:95], v25
    ds_read_b64_tr_b16 v[184:185], v4 offset:30720
    ds_read_b64_tr_b16 v[186:187], v4 offset:31232
    v_mfma_f32_32x32x16_bf16 v[48:63], v[76:79], v[156:159], v[48:63]
    ds_read_b64_tr_b16 v[188:189], v5 offset:30720
    ds_read_b64_tr_b16 v[190:191], v5 offset:31232
    s_waitcnt vmcnt(15) lgkmcnt(0)
    s_barrier
    s_add_u32 s40, s39, 24576
    s_mov_b32 m0, s40
    s_mov_b32 s41, 1179648
    buffer_load_dwordx4 v3, s[16:19], s41 offen lds
    s_add_u32 s40, s39, 25600
    s_mov_b32 m0, s40
    s_mov_b32 s41, 1187840
    buffer_load_dwordx4 v3, s[16:19], s41 offen lds
    s_add_u32 s40, s47, 40960
    s_mov_b32 m0, s40
    s_mov_b32 s42, 384
    buffer_load_dwordx4 v2, s[12:15], s42 offen lds
    s_add_u32 s40, s47, 41984
    s_mov_b32 m0, s40
    s_mov_b32 s42, 16768
    buffer_load_dwordx4 v16, s[12:15], s42 offen lds
    s_add_u32 s40, s47, 43008
    s_mov_b32 m0, s40
    s_mov_b32 s42, 33152
    buffer_load_dwordx4 v2, s[12:15], s42 offen lds
    s_add_u32 s40, s47, 44032
    s_mov_b32 m0, s40
    s_mov_b32 s42, 49536
    buffer_load_dwordx4 v16, s[12:15], s42 offen lds
    v_mfma_f32_32x32x16_bf16 v[32:47], v[80:83], v[160:163], v[32:47]
    v_add_u32 v25, 92160, v17
    ds_read_b128 v[64:67], v25
    ds_read_b64_tr_b16 v[128:129], v4 offset:32768
    ds_read_b64_tr_b16 v[130:131], v4 offset:33280
    v_mfma_f32_32x32x16_bf16 v[48:63], v[80:83], v[164:167], v[48:63]
    ds_read_b64_tr_b16 v[132:133], v5 offset:32768
    ds_read_b64_tr_b16 v[134:135], v5 offset:33280
    v_mfma_f32_32x32x16_bf16 v[32:47], v[84:87], v[168:171], v[32:47]
    v_add_u32 v25, 92160, v18
    ds_read_b128 v[68:71], v25
    ds_read_b64_tr_b16 v[136:137], v4 offset:34816
    ds_read_b64_tr_b16 v[138:139], v4 offset:35328
    v_mfma_f32_32x32x16_bf16 v[48:63], v[84:87], v[172:175], v[48:63]
    ds_read_b64_tr_b16 v[140:141], v5 offset:34816
    ds_read_b64_tr_b16 v[142:143], v5 offset:35328
    v_mfma_f32_32x32x16_bf16 v[32:47], v[88:91], v[176:179], v[32:47]
    v_add_u32 v25, 92160, v19
    ds_read_b128 v[72:75], v25
    ds_read_b64_tr_b16 v[144:145], v4 offset:36864
    ds_read_b64_tr_b16 v[146:147], v4 offset:37376
    v_mfma_f32_32x32x16_bf16 v[48:63], v[88:91], v[180:183], v[48:63]
    ds_read_b64_tr_b16 v[148:149], v5 offset:36864
    ds_read_b64_tr_b16 v[150:151], v5 offset:37376
    v_mfma_f32_32x32x16_bf16 v[32:47], v[92:95], v[184:187], v[32:47]
    v_add_u32 v25, 92160, v20
    ds_read_b128 v[76:79], v25
    ds_read_b64_tr_b16 v[152:153], v4 offset:38912
    ds_read_b64_tr_b16 v[154:155], v4 offset:39424
    v_mfma_f32_32x32x16_bf16 v[48:63], v[92:95], v[188:191], v[48:63]
    ds_read_b64_tr_b16 v[156:157], v5 offset:38912
    ds_read_b64_tr_b16 v[158:159], v5 offset:39424
    s_waitcnt vmcnt(19) lgkmcnt(0)
    s_barrier
    s_add_u32 s40, s39, 32768
    s_mov_b32 m0, s40
    s_mov_b32 s41, 196608
    buffer_load_dwordx4 v3, s[16:19], s41 offen lds
    s_add_u32 s40, s39, 33792
    s_mov_b32 m0, s40
    s_mov_b32 s41, 204800
    buffer_load_dwordx4 v3, s[16:19], s41 offen lds
    s_add_u32 s40, s47, 58368
    s_mov_b32 m0, s40
    s_mov_b32 s42, 1408
    buffer_load_dwordx4 v2, s[12:15], s42 offen lds
    s_add_u32 s40, s47, 59392
    s_mov_b32 m0, s40
    s_mov_b32 s42, 17792
    buffer_load_dwordx4 v16, s[12:15], s42 offen lds
    s_add_u32 s40, s47, 60416
    s_mov_b32 m0, s40
    s_mov_b32 s42, 34176
    buffer_load_dwordx4 v2, s[12:15], s42 offen lds
    s_add_u32 s40, s47, 61440
    s_mov_b32 m0, s40
    s_mov_b32 s42, 50560
    buffer_load_dwordx4 v16, s[12:15], s42 offen lds
    v_mfma_f32_32x32x16_bf16 v[32:47], v[64:67], v[128:131], v[32:47]
    v_add_u32 v25, 74752, v21
    ds_read_b128 v[80:83], v25
    ds_read_b64_tr_b16 v[160:161], v4 offset:0
    ds_read_b64_tr_b16 v[162:163], v4 offset:512
    v_mfma_f32_32x32x16_bf16 v[48:63], v[64:67], v[132:135], v[48:63]
    ds_read_b64_tr_b16 v[164:165], v5 offset:0
    ds_read_b64_tr_b16 v[166:167], v5 offset:512
    v_mfma_f32_32x32x16_bf16 v[32:47], v[68:71], v[136:139], v[32:47]
    v_add_u32 v25, 74752, v22
    ds_read_b128 v[84:87], v25
    ds_read_b64_tr_b16 v[168:169], v4 offset:2048
    ds_read_b64_tr_b16 v[170:171], v4 offset:2560
    v_mfma_f32_32x32x16_bf16 v[48:63], v[68:71], v[140:143], v[48:63]
    ds_read_b64_tr_b16 v[172:173], v5 offset:2048
    ds_read_b64_tr_b16 v[174:175], v5 offset:2560
    v_mfma_f32_32x32x16_bf16 v[32:47], v[72:75], v[144:147], v[32:47]
    v_add_u32 v25, 74752, v23
    ds_read_b128 v[88:91], v25
    ds_read_b64_tr_b16 v[176:177], v4 offset:4096
    ds_read_b64_tr_b16 v[178:179], v4 offset:4608
    v_mfma_f32_32x32x16_bf16 v[48:63], v[72:75], v[148:151], v[48:63]
    ds_read_b64_tr_b16 v[180:181], v5 offset:4096
    ds_read_b64_tr_b16 v[182:183], v5 offset:4608
    v_mfma_f32_32x32x16_bf16 v[32:47], v[76:79], v[152:155], v[32:47]
    v_add_u32 v25, 74752, v24
    ds_read_b128 v[92:95], v25
    ds_read_b64_tr_b16 v[184:185], v4 offset:6144
    ds_read_b64_tr_b16 v[186:187], v4 offset:6656
    v_mfma_f32_32x32x16_bf16 v[48:63], v[76:79], v[156:159], v[48:63]
    ds_read_b64_tr_b16 v[188:189], v5 offset:6144
    ds_read_b64_tr_b16 v[190:191], v5 offset:6656
    s_waitcnt vmcnt(12) lgkmcnt(0)
    s_barrier
    s_add_u32 s40, s39, 0
    s_mov_b32 m0, s40
    s_mov_b32 s41, 720896
    buffer_load_dwordx4 v3, s[16:19], s41 offen lds
    s_add_u32 s40, s39, 1024
    s_mov_b32 m0, s40
    s_mov_b32 s41, 729088
    buffer_load_dwordx4 v3, s[16:19], s41 offen lds
    s_mov_b32 m0, 57344
    s_add_u32 s42, s56, 384
    buffer_load_dwordx4 v2, s[12:15], s42 offen lds
    v_mfma_f32_32x32x16_bf16 v[32:47], v[80:83], v[160:163], v[32:47]
    v_add_u32 v25, 108544, v17
    ds_read_b128 v[64:67], v25
    ds_read_b64_tr_b16 v[128:129], v4 offset:8192
    ds_read_b64_tr_b16 v[130:131], v4 offset:8704
    v_mfma_f32_32x32x16_bf16 v[48:63], v[80:83], v[164:167], v[48:63]
    ds_read_b64_tr_b16 v[132:133], v5 offset:8192
    ds_read_b64_tr_b16 v[134:135], v5 offset:8704
    v_mfma_f32_32x32x16_bf16 v[32:47], v[84:87], v[168:171], v[32:47]
    v_add_u32 v25, 108544, v18
    ds_read_b128 v[68:71], v25
    ds_read_b64_tr_b16 v[136:137], v4 offset:10240
    ds_read_b64_tr_b16 v[138:139], v4 offset:10752
    v_mfma_f32_32x32x16_bf16 v[48:63], v[84:87], v[172:175], v[48:63]
    ds_read_b64_tr_b16 v[140:141], v5 offset:10240
    ds_read_b64_tr_b16 v[142:143], v5 offset:10752
    v_mfma_f32_32x32x16_bf16 v[32:47], v[88:91], v[176:179], v[32:47]
    v_add_u32 v25, 108544, v19
    ds_read_b128 v[72:75], v25
    ds_read_b64_tr_b16 v[144:145], v4 offset:12288
    ds_read_b64_tr_b16 v[146:147], v4 offset:12800
    v_mfma_f32_32x32x16_bf16 v[48:63], v[88:91], v[180:183], v[48:63]
    ds_read_b64_tr_b16 v[148:149], v5 offset:12288
    ds_read_b64_tr_b16 v[150:151], v5 offset:12800
    v_mfma_f32_32x32x16_bf16 v[32:47], v[92:95], v[184:187], v[32:47]
    v_add_u32 v25, 108544, v20
    ds_read_b128 v[76:79], v25
    ds_read_b64_tr_b16 v[152:153], v4 offset:14336
    ds_read_b64_tr_b16 v[154:155], v4 offset:14848
    v_mfma_f32_32x32x16_bf16 v[48:63], v[92:95], v[188:191], v[48:63]
    ds_read_b64_tr_b16 v[156:157], v5 offset:14336
    ds_read_b64_tr_b16 v[158:159], v5 offset:14848
    s_waitcnt vmcnt(15) lgkmcnt(0)
    s_barrier
    s_add_u32 s40, s39, 8192
    s_mov_b32 m0, s40
    s_mov_b32 s41, 1245184
    buffer_load_dwordx4 v3, s[16:19], s41 offen lds
    s_add_u32 s40, s39, 9216
    s_mov_b32 m0, s40
    s_mov_b32 s41, 1253376
    buffer_load_dwordx4 v3, s[16:19], s41 offen lds
    s_add_u32 s40, s47, 74752
    s_mov_b32 m0, s40
    s_mov_b32 s42, 512
    buffer_load_dwordx4 v2, s[12:15], s42 offen lds
    s_add_u32 s40, s47, 75776
    s_mov_b32 m0, s40
    s_mov_b32 s42, 16896
    buffer_load_dwordx4 v16, s[12:15], s42 offen lds
    s_add_u32 s40, s47, 76800
    s_mov_b32 m0, s40
    s_mov_b32 s42, 33280
    buffer_load_dwordx4 v2, s[12:15], s42 offen lds
    s_add_u32 s40, s47, 77824
    s_mov_b32 m0, s40
    s_mov_b32 s42, 49664
    buffer_load_dwordx4 v16, s[12:15], s42 offen lds
    v_mfma_f32_32x32x16_bf16 v[32:47], v[64:67], v[128:131], v[32:47]
    v_add_u32 v25, 125952, v17
    ds_read_b128 v[80:83], v25
    ds_read_b64_tr_b16 v[160:161], v4 offset:16384
    ds_read_b64_tr_b16 v[162:163], v4 offset:16896
    v_mfma_f32_32x32x16_bf16 v[48:63], v[64:67], v[132:135], v[48:63]
    ds_read_b64_tr_b16 v[164:165], v5 offset:16384
    ds_read_b64_tr_b16 v[166:167], v5 offset:16896
    v_mfma_f32_32x32x16_bf16 v[32:47], v[68:71], v[136:139], v[32:47]
    v_add_u32 v25, 125952, v18
    ds_read_b128 v[84:87], v25
    ds_read_b64_tr_b16 v[168:169], v4 offset:18432
    ds_read_b64_tr_b16 v[170:171], v4 offset:18944
    v_mfma_f32_32x32x16_bf16 v[48:63], v[68:71], v[140:143], v[48:63]
    ds_read_b64_tr_b16 v[172:173], v5 offset:18432
    ds_read_b64_tr_b16 v[174:175], v5 offset:18944
    v_mfma_f32_32x32x16_bf16 v[32:47], v[72:75], v[144:147], v[32:47]
    v_add_u32 v25, 125952, v19
    ds_read_b128 v[88:91], v25
    ds_read_b64_tr_b16 v[176:177], v4 offset:20480
    ds_read_b64_tr_b16 v[178:179], v4 offset:20992
    v_mfma_f32_32x32x16_bf16 v[48:63], v[72:75], v[148:151], v[48:63]
    ds_read_b64_tr_b16 v[180:181], v5 offset:20480
    ds_read_b64_tr_b16 v[182:183], v5 offset:20992
    v_mfma_f32_32x32x16_bf16 v[32:47], v[76:79], v[152:155], v[32:47]
    v_add_u32 v25, 125952, v20
    ds_read_b128 v[92:95], v25
    ds_read_b64_tr_b16 v[184:185], v4 offset:22528
    ds_read_b64_tr_b16 v[186:187], v4 offset:23040
    v_mfma_f32_32x32x16_bf16 v[48:63], v[76:79], v[156:159], v[48:63]
    ds_read_b64_tr_b16 v[188:189], v5 offset:22528
    ds_read_b64_tr_b16 v[190:191], v5 offset:23040
    s_waitcnt vmcnt(19) lgkmcnt(0)
    s_barrier
    s_add_u32 s40, s39, 16384
    s_mov_b32 m0, s40
    s_mov_b32 s41, 262144
    buffer_load_dwordx4 v3, s[16:19], s41 offen lds
    s_add_u32 s40, s39, 17408
    s_mov_b32 m0, s40
    s_mov_b32 s41, 270336
    buffer_load_dwordx4 v3, s[16:19], s41 offen lds
    s_add_u32 s40, s47, 92160
    s_mov_b32 m0, s40
    s_mov_b32 s42, 1536
    buffer_load_dwordx4 v2, s[12:15], s42 offen lds
    s_add_u32 s40, s47, 93184
    s_mov_b32 m0, s40
    s_mov_b32 s42, 17920
    buffer_load_dwordx4 v16, s[12:15], s42 offen lds
    s_add_u32 s40, s47, 94208
    s_mov_b32 m0, s40
    s_mov_b32 s42, 34304
    buffer_load_dwordx4 v2, s[12:15], s42 offen lds
    s_add_u32 s40, s47, 95232
    s_mov_b32 m0, s40
    s_mov_b32 s42, 50688
    buffer_load_dwordx4 v16, s[12:15], s42 offen lds
    v_mfma_f32_32x32x16_bf16 v[32:47], v[80:83], v[160:163], v[32:47]
    v_add_u32 v25, 108544, v21
    ds_read_b128 v[64:67], v25
    ds_read_b64_tr_b16 v[128:129], v4 offset:24576
    ds_read_b64_tr_b16 v[130:131], v4 offset:25088
    v_mfma_f32_32x32x16_bf16 v[48:63], v[80:83], v[164:167], v[48:63]
    ds_read_b64_tr_b16 v[132:133], v5 offset:24576
    ds_read_b64_tr_b16 v[134:135], v5 offset:25088
    v_mfma_f32_32x32x16_bf16 v[32:47], v[84:87], v[168:171], v[32:47]
    v_add_u32 v25, 108544, v22
    ds_read_b128 v[68:71], v25
    ds_read_b64_tr_b16 v[136:137], v4 offset:26624
    ds_read_b64_tr_b16 v[138:139], v4 offset:27136
    v_mfma_f32_32x32x16_bf16 v[48:63], v[84:87], v[172:175], v[48:63]
    ds_read_b64_tr_b16 v[140:141], v5 offset:26624
    ds_read_b64_tr_b16 v[142:143], v5 offset:27136
    v_mfma_f32_32x32x16_bf16 v[32:47], v[88:91], v[176:179], v[32:47]
    v_add_u32 v25, 108544, v23
    ds_read_b128 v[72:75], v25
    ds_read_b64_tr_b16 v[144:145], v4 offset:28672
    ds_read_b64_tr_b16 v[146:147], v4 offset:29184
    v_mfma_f32_32x32x16_bf16 v[48:63], v[88:91], v[180:183], v[48:63]
    ds_read_b64_tr_b16 v[148:149], v5 offset:28672
    ds_read_b64_tr_b16 v[150:151], v5 offset:29184
    v_mfma_f32_32x32x16_bf16 v[32:47], v[92:95], v[184:187], v[32:47]
    v_add_u32 v25, 108544, v24
    ds_read_b128 v[76:79], v25
    ds_read_b64_tr_b16 v[152:153], v4 offset:30720
    ds_read_b64_tr_b16 v[154:155], v4 offset:31232
    v_mfma_f32_32x32x16_bf16 v[48:63], v[92:95], v[188:191], v[48:63]
    ds_read_b64_tr_b16 v[156:157], v5 offset:30720
    ds_read_b64_tr_b16 v[158:159], v5 offset:31232
    s_waitcnt vmcnt(12) lgkmcnt(0)
    s_barrier
    s_add_u32 s40, s39, 24576
    s_mov_b32 m0, s40
    s_mov_b32 s41, 786432
    buffer_load_dwordx4 v3, s[16:19], s41 offen lds
    s_add_u32 s40, s39, 25600
    s_mov_b32 m0, s40
    s_mov_b32 s41, 794624
    buffer_load_dwordx4 v3, s[16:19], s41 offen lds
    s_mov_b32 m0, 91136
    s_add_u32 s42, s56, 512
    buffer_load_dwordx4 v2, s[12:15], s42 offen lds
    v_mfma_f32_32x32x16_bf16 v[32:47], v[64:67], v[128:131], v[32:47]
    v_add_u32 v25, 40960, v17
    ds_read_b128 v[80:83], v25
    ds_read_b64_tr_b16 v[160:161], v4 offset:32768
    ds_read_b64_tr_b16 v[162:163], v4 offset:33280
    v_mfma_f32_32x32x16_bf16 v[48:63], v[64:67], v[132:135], v[48:63]
    ds_read_b64_tr_b16 v[164:165], v5 offset:32768
    ds_read_b64_tr_b16 v[166:167], v5 offset:33280
    v_mfma_f32_32x32x16_bf16 v[32:47], v[68:71], v[136:139], v[32:47]
    v_add_u32 v25, 40960, v18
    ds_read_b128 v[84:87], v25
    ds_read_b64_tr_b16 v[168:169], v4 offset:34816
    ds_read_b64_tr_b16 v[170:171], v4 offset:35328
    v_mfma_f32_32x32x16_bf16 v[48:63], v[68:71], v[140:143], v[48:63]
    ds_read_b64_tr_b16 v[172:173], v5 offset:34816
    ds_read_b64_tr_b16 v[174:175], v5 offset:35328
    v_mfma_f32_32x32x16_bf16 v[32:47], v[72:75], v[144:147], v[32:47]
    v_add_u32 v25, 40960, v19
    ds_read_b128 v[88:91], v25
    ds_read_b64_tr_b16 v[176:177], v4 offset:36864
    ds_read_b64_tr_b16 v[178:179], v4 offset:37376
    v_mfma_f32_32x32x16_bf16 v[48:63], v[72:75], v[148:151], v[48:63]
    ds_read_b64_tr_b16 v[180:181], v5 offset:36864
    ds_read_b64_tr_b16 v[182:183], v5 offset:37376
    v_mfma_f32_32x32x16_bf16 v[32:47], v[76:79], v[152:155], v[32:47]
    v_add_u32 v25, 40960, v20
    ds_read_b128 v[92:95], v25
    ds_read_b64_tr_b16 v[184:185], v4 offset:38912
    ds_read_b64_tr_b16 v[186:187], v4 offset:39424
    v_mfma_f32_32x32x16_bf16 v[48:63], v[76:79], v[156:159], v[48:63]
    ds_read_b64_tr_b16 v[188:189], v5 offset:38912
    ds_read_b64_tr_b16 v[190:191], v5 offset:39424
    s_waitcnt vmcnt(15) lgkmcnt(0)
    s_barrier
    s_add_u32 s40, s39, 32768
    s_mov_b32 m0, s40
    s_mov_b32 s41, 1310720
    buffer_load_dwordx4 v3, s[16:19], s41 offen lds
    s_add_u32 s40, s39, 33792
    s_mov_b32 m0, s40
    s_mov_b32 s41, 1318912
    buffer_load_dwordx4 v3, s[16:19], s41 offen lds
    s_add_u32 s40, s47, 108544
    s_mov_b32 m0, s40
    s_mov_b32 s42, 640
    buffer_load_dwordx4 v2, s[12:15], s42 offen lds
    s_add_u32 s40, s47, 109568
    s_mov_b32 m0, s40
    s_mov_b32 s42, 17024
    buffer_load_dwordx4 v16, s[12:15], s42 offen lds
    s_add_u32 s40, s47, 110592
    s_mov_b32 m0, s40
    s_mov_b32 s42, 33408
    buffer_load_dwordx4 v2, s[12:15], s42 offen lds
    s_add_u32 s40, s47, 111616
    s_mov_b32 m0, s40
    s_mov_b32 s42, 49792
    buffer_load_dwordx4 v16, s[12:15], s42 offen lds
    v_mfma_f32_32x32x16_bf16 v[32:47], v[80:83], v[160:163], v[32:47]
    v_add_u32 v25, 58368, v17
    ds_read_b128 v[64:67], v25
    ds_read_b64_tr_b16 v[128:129], v4 offset:0
    ds_read_b64_tr_b16 v[130:131], v4 offset:512
    v_mfma_f32_32x32x16_bf16 v[48:63], v[80:83], v[164:167], v[48:63]
    ds_read_b64_tr_b16 v[132:133], v5 offset:0
    ds_read_b64_tr_b16 v[134:135], v5 offset:512
    v_mfma_f32_32x32x16_bf16 v[32:47], v[84:87], v[168:171], v[32:47]
    v_add_u32 v25, 58368, v18
    ds_read_b128 v[68:71], v25
    ds_read_b64_tr_b16 v[136:137], v4 offset:2048
    ds_read_b64_tr_b16 v[138:139], v4 offset:2560
    v_mfma_f32_32x32x16_bf16 v[48:63], v[84:87], v[172:175], v[48:63]
    ds_read_b64_tr_b16 v[140:141], v5 offset:2048
    ds_read_b64_tr_b16 v[142:143], v5 offset:2560
    v_mfma_f32_32x32x16_bf16 v[32:47], v[88:91], v[176:179], v[32:47]
    v_add_u32 v25, 58368, v19
    ds_read_b128 v[72:75], v25
    ds_read_b64_tr_b16 v[144:145], v4 offset:4096
    ds_read_b64_tr_b16 v[146:147], v4 offset:4608
    v_mfma_f32_32x32x16_bf16 v[48:63], v[88:91], v[180:183], v[48:63]
    ds_read_b64_tr_b16 v[148:149], v5 offset:4096
    ds_read_b64_tr_b16 v[150:151], v5 offset:4608
    v_mfma_f32_32x32x16_bf16 v[32:47], v[92:95], v[184:187], v[32:47]
    v_add_u32 v25, 58368, v20
    ds_read_b128 v[76:79], v25
    ds_read_b64_tr_b16 v[152:153], v4 offset:6144
    ds_read_b64_tr_b16 v[154:155], v4 offset:6656
    v_mfma_f32_32x32x16_bf16 v[48:63], v[92:95], v[188:191], v[48:63]
    ds_read_b64_tr_b16 v[156:157], v5 offset:6144
    ds_read_b64_tr_b16 v[158:159], v5 offset:6656
    s_waitcnt vmcnt(19) lgkmcnt(0)
    s_barrier
    s_add_u32 s40, s39, 0
    s_mov_b32 m0, s40
    s_mov_b32 s41, 327680
    buffer_load_dwordx4 v3, s[16:19], s41 offen lds
    s_add_u32 s40, s39, 1024
    s_mov_b32 m0, s40
    s_mov_b32 s41, 335872
    buffer_load_dwordx4 v3, s[16:19], s41 offen lds
    s_add_u32 s40, s47, 125952
    s_mov_b32 m0, s40
    s_mov_b32 s42, 1664
    buffer_load_dwordx4 v2, s[12:15], s42 offen lds
    s_add_u32 s40, s47, 126976
    s_mov_b32 m0, s40
    s_mov_b32 s42, 18048
    buffer_load_dwordx4 v16, s[12:15], s42 offen lds
    s_add_u32 s40, s47, 128000
    s_mov_b32 m0, s40
    s_mov_b32 s42, 34432
    buffer_load_dwordx4 v2, s[12:15], s42 offen lds
    s_add_u32 s40, s47, 129024
    s_mov_b32 m0, s40
    s_mov_b32 s42, 50816
    buffer_load_dwordx4 v16, s[12:15], s42 offen lds
    v_mfma_f32_32x32x16_bf16 v[32:47], v[64:67], v[128:131], v[32:47]
    v_add_u32 v25, 40960, v21
    ds_read_b128 v[80:83], v25
    ds_read_b64_tr_b16 v[160:161], v4 offset:8192
    ds_read_b64_tr_b16 v[162:163], v4 offset:8704
    v_mfma_f32_32x32x16_bf16 v[48:63], v[64:67], v[132:135], v[48:63]
    ds_read_b64_tr_b16 v[164:165], v5 offset:8192
    ds_read_b64_tr_b16 v[166:167], v5 offset:8704
    v_mfma_f32_32x32x16_bf16 v[32:47], v[68:71], v[136:139], v[32:47]
    v_add_u32 v25, 40960, v22
    ds_read_b128 v[84:87], v25
    ds_read_b64_tr_b16 v[168:169], v4 offset:10240
    ds_read_b64_tr_b16 v[170:171], v4 offset:10752
    v_mfma_f32_32x32x16_bf16 v[48:63], v[68:71], v[140:143], v[48:63]
    ds_read_b64_tr_b16 v[172:173], v5 offset:10240
    ds_read_b64_tr_b16 v[174:175], v5 offset:10752
    v_mfma_f32_32x32x16_bf16 v[32:47], v[72:75], v[144:147], v[32:47]
    v_add_u32 v25, 40960, v23
    ds_read_b128 v[88:91], v25
    ds_read_b64_tr_b16 v[176:177], v4 offset:12288
    ds_read_b64_tr_b16 v[178:179], v4 offset:12800
    v_mfma_f32_32x32x16_bf16 v[48:63], v[72:75], v[148:151], v[48:63]
    ds_read_b64_tr_b16 v[180:181], v5 offset:12288
    ds_read_b64_tr_b16 v[182:183], v5 offset:12800
    v_mfma_f32_32x32x16_bf16 v[32:47], v[76:79], v[152:155], v[32:47]
    v_add_u32 v25, 40960, v24
    ds_read_b128 v[92:95], v25
    ds_read_b64_tr_b16 v[184:185], v4 offset:14336
    ds_read_b64_tr_b16 v[186:187], v4 offset:14848
    v_mfma_f32_32x32x16_bf16 v[48:63], v[76:79], v[156:159], v[48:63]
    ds_read_b64_tr_b16 v[188:189], v5 offset:14336
    ds_read_b64_tr_b16 v[190:191], v5 offset:14848
    s_waitcnt vmcnt(12) lgkmcnt(0)
    s_barrier
    s_add_u32 s40, s39, 8192
    s_mov_b32 m0, s40
    s_mov_b32 s41, 851968
    buffer_load_dwordx4 v3, s[16:19], s41 offen lds
    s_add_u32 s40, s39, 9216
    s_mov_b32 m0, s40
    s_mov_b32 s41, 860160
    buffer_load_dwordx4 v3, s[16:19], s41 offen lds
    s_mov_b32 m0, 124928
    s_add_u32 s42, s56, 640
    buffer_load_dwordx4 v2, s[12:15], s42 offen lds
    v_mfma_f32_32x32x16_bf16 v[32:47], v[80:83], v[160:163], v[32:47]
    v_add_u32 v25, 74752, v17
    ds_read_b128 v[64:67], v25
    ds_read_b64_tr_b16 v[128:129], v4 offset:16384
    ds_read_b64_tr_b16 v[130:131], v4 offset:16896
    v_mfma_f32_32x32x16_bf16 v[48:63], v[80:83], v[164:167], v[48:63]
    ds_read_b64_tr_b16 v[132:133], v5 offset:16384
    ds_read_b64_tr_b16 v[134:135], v5 offset:16896
    v_mfma_f32_32x32x16_bf16 v[32:47], v[84:87], v[168:171], v[32:47]
    v_add_u32 v25, 74752, v18
    ds_read_b128 v[68:71], v25
    ds_read_b64_tr_b16 v[136:137], v4 offset:18432
    ds_read_b64_tr_b16 v[138:139], v4 offset:18944
    v_mfma_f32_32x32x16_bf16 v[48:63], v[84:87], v[172:175], v[48:63]
    ds_read_b64_tr_b16 v[140:141], v5 offset:18432
    ds_read_b64_tr_b16 v[142:143], v5 offset:18944
    v_mfma_f32_32x32x16_bf16 v[32:47], v[88:91], v[176:179], v[32:47]
    v_add_u32 v25, 74752, v19
    ds_read_b128 v[72:75], v25
    ds_read_b64_tr_b16 v[144:145], v4 offset:20480
    ds_read_b64_tr_b16 v[146:147], v4 offset:20992
    v_mfma_f32_32x32x16_bf16 v[48:63], v[88:91], v[180:183], v[48:63]
    ds_read_b64_tr_b16 v[148:149], v5 offset:20480
    ds_read_b64_tr_b16 v[150:151], v5 offset:20992
    v_mfma_f32_32x32x16_bf16 v[32:47], v[92:95], v[184:187], v[32:47]
    v_add_u32 v25, 74752, v20
    ds_read_b128 v[76:79], v25
    ds_read_b64_tr_b16 v[152:153], v4 offset:22528
    ds_read_b64_tr_b16 v[154:155], v4 offset:23040
    v_mfma_f32_32x32x16_bf16 v[48:63], v[92:95], v[188:191], v[48:63]
    ds_read_b64_tr_b16 v[156:157], v5 offset:22528
    ds_read_b64_tr_b16 v[158:159], v5 offset:23040
    s_waitcnt vmcnt(15) lgkmcnt(0)
    s_barrier
    s_add_u32 s40, s39, 16384
    s_mov_b32 m0, s40
    s_mov_b32 s41, 1376256
    buffer_load_dwordx4 v3, s[16:19], s41 offen lds
    s_add_u32 s40, s39, 17408
    s_mov_b32 m0, s40
    s_mov_b32 s41, 1384448
    buffer_load_dwordx4 v3, s[16:19], s41 offen lds
    s_add_u32 s40, s47, 40960
    s_mov_b32 m0, s40
    s_mov_b32 s42, 768
    buffer_load_dwordx4 v2, s[12:15], s42 offen lds
    s_add_u32 s40, s47, 41984
    s_mov_b32 m0, s40
    s_mov_b32 s42, 17152
    buffer_load_dwordx4 v16, s[12:15], s42 offen lds
    s_add_u32 s40, s47, 43008
    s_mov_b32 m0, s40
    s_mov_b32 s42, 33536
    buffer_load_dwordx4 v2, s[12:15], s42 offen lds
    s_add_u32 s40, s47, 44032
    s_mov_b32 m0, s40
    s_mov_b32 s42, 49920
    buffer_load_dwordx4 v16, s[12:15], s42 offen lds
    v_mfma_f32_32x32x16_bf16 v[32:47], v[64:67], v[128:131], v[32:47]
    v_add_u32 v25, 92160, v17
    ds_read_b128 v[80:83], v25
    ds_read_b64_tr_b16 v[160:161], v4 offset:24576
    ds_read_b64_tr_b16 v[162:163], v4 offset:25088
    v_mfma_f32_32x32x16_bf16 v[48:63], v[64:67], v[132:135], v[48:63]
    ds_read_b64_tr_b16 v[164:165], v5 offset:24576
    ds_read_b64_tr_b16 v[166:167], v5 offset:25088
    v_mfma_f32_32x32x16_bf16 v[32:47], v[68:71], v[136:139], v[32:47]
    v_add_u32 v25, 92160, v18
    ds_read_b128 v[84:87], v25
    ds_read_b64_tr_b16 v[168:169], v4 offset:26624
    ds_read_b64_tr_b16 v[170:171], v4 offset:27136
    v_mfma_f32_32x32x16_bf16 v[48:63], v[68:71], v[140:143], v[48:63]
    ds_read_b64_tr_b16 v[172:173], v5 offset:26624
    ds_read_b64_tr_b16 v[174:175], v5 offset:27136
    v_mfma_f32_32x32x16_bf16 v[32:47], v[72:75], v[144:147], v[32:47]
    v_add_u32 v25, 92160, v19
    ds_read_b128 v[88:91], v25
    ds_read_b64_tr_b16 v[176:177], v4 offset:28672
    ds_read_b64_tr_b16 v[178:179], v4 offset:29184
    v_mfma_f32_32x32x16_bf16 v[48:63], v[72:75], v[148:151], v[48:63]
    ds_read_b64_tr_b16 v[180:181], v5 offset:28672
    ds_read_b64_tr_b16 v[182:183], v5 offset:29184
    v_mfma_f32_32x32x16_bf16 v[32:47], v[76:79], v[152:155], v[32:47]
    v_add_u32 v25, 92160, v20
    ds_read_b128 v[92:95], v25
    ds_read_b64_tr_b16 v[184:185], v4 offset:30720
    ds_read_b64_tr_b16 v[186:187], v4 offset:31232
    v_mfma_f32_32x32x16_bf16 v[48:63], v[76:79], v[156:159], v[48:63]
    ds_read_b64_tr_b16 v[188:189], v5 offset:30720
    ds_read_b64_tr_b16 v[190:191], v5 offset:31232
    s_waitcnt vmcnt(19) lgkmcnt(0)
    s_barrier
    s_add_u32 s40, s39, 24576
    s_mov_b32 m0, s40
    s_mov_b32 s41, 393216
    buffer_load_dwordx4 v3, s[16:19], s41 offen lds
    s_add_u32 s40, s39, 25600
    s_mov_b32 m0, s40
    s_mov_b32 s41, 401408
    buffer_load_dwordx4 v3, s[16:19], s41 offen lds
    s_add_u32 s40, s47, 58368
    s_mov_b32 m0, s40
    s_mov_b32 s42, 1792
    buffer_load_dwordx4 v2, s[12:15], s42 offen lds
    s_add_u32 s40, s47, 59392
    s_mov_b32 m0, s40
    s_mov_b32 s42, 18176
    buffer_load_dwordx4 v16, s[12:15], s42 offen lds
    s_add_u32 s40, s47, 60416
    s_mov_b32 m0, s40
    s_mov_b32 s42, 34560
    buffer_load_dwordx4 v2, s[12:15], s42 offen lds
    s_add_u32 s40, s47, 61440
    s_mov_b32 m0, s40
    s_mov_b32 s42, 50944
    buffer_load_dwordx4 v16, s[12:15], s42 offen lds
    v_mfma_f32_32x32x16_bf16 v[32:47], v[80:83], v[160:163], v[32:47]
    v_add_u32 v25, 74752, v21
    ds_read_b128 v[64:67], v25
    ds_read_b64_tr_b16 v[128:129], v4 offset:32768
    ds_read_b64_tr_b16 v[130:131], v4 offset:33280
    v_mfma_f32_32x32x16_bf16 v[48:63], v[80:83], v[164:167], v[48:63]
    ds_read_b64_tr_b16 v[132:133], v5 offset:32768
    ds_read_b64_tr_b16 v[134:135], v5 offset:33280
    v_mfma_f32_32x32x16_bf16 v[32:47], v[84:87], v[168:171], v[32:47]
    v_add_u32 v25, 74752, v22
    ds_read_b128 v[68:71], v25
    ds_read_b64_tr_b16 v[136:137], v4 offset:34816
    ds_read_b64_tr_b16 v[138:139], v4 offset:35328
    v_mfma_f32_32x32x16_bf16 v[48:63], v[84:87], v[172:175], v[48:63]
    ds_read_b64_tr_b16 v[140:141], v5 offset:34816
    ds_read_b64_tr_b16 v[142:143], v5 offset:35328
    v_mfma_f32_32x32x16_bf16 v[32:47], v[88:91], v[176:179], v[32:47]
    v_add_u32 v25, 74752, v23
    ds_read_b128 v[72:75], v25
    ds_read_b64_tr_b16 v[144:145], v4 offset:36864
    ds_read_b64_tr_b16 v[146:147], v4 offset:37376
    v_mfma_f32_32x32x16_bf16 v[48:63], v[88:91], v[180:183], v[48:63]
    ds_read_b64_tr_b16 v[148:149], v5 offset:36864
    ds_read_b64_tr_b16 v[150:151], v5 offset:37376
    v_mfma_f32_32x32x16_bf16 v[32:47], v[92:95], v[184:187], v[32:47]
    v_add_u32 v25, 74752, v24
    ds_read_b128 v[76:79], v25
    ds_read_b64_tr_b16 v[152:153], v4 offset:38912
    ds_read_b64_tr_b16 v[154:155], v4 offset:39424
    v_mfma_f32_32x32x16_bf16 v[48:63], v[92:95], v[188:191], v[48:63]
    ds_read_b64_tr_b16 v[156:157], v5 offset:38912
    ds_read_b64_tr_b16 v[158:159], v5 offset:39424
    s_waitcnt vmcnt(12) lgkmcnt(0)
    s_barrier
    s_add_u32 s40, s39, 32768
    s_mov_b32 m0, s40
    s_mov_b32 s41, 917504
    buffer_load_dwordx4 v3, s[16:19], s41 offen lds
    s_add_u32 s40, s39, 33792
    s_mov_b32 m0, s40
    s_mov_b32 s41, 925696
    buffer_load_dwordx4 v3, s[16:19], s41 offen lds
    s_mov_b32 m0, 57344
    s_add_u32 s42, s56, 768
    buffer_load_dwordx4 v2, s[12:15], s42 offen lds
    v_mfma_f32_32x32x16_bf16 v[32:47], v[64:67], v[128:131], v[32:47]
    v_add_u32 v25, 108544, v17
    ds_read_b128 v[80:83], v25
    ds_read_b64_tr_b16 v[160:161], v4 offset:0
    ds_read_b64_tr_b16 v[162:163], v4 offset:512
    v_mfma_f32_32x32x16_bf16 v[48:63], v[64:67], v[132:135], v[48:63]
    ds_read_b64_tr_b16 v[164:165], v5 offset:0
    ds_read_b64_tr_b16 v[166:167], v5 offset:512
    v_mfma_f32_32x32x16_bf16 v[32:47], v[68:71], v[136:139], v[32:47]
    v_add_u32 v25, 108544, v18
    ds_read_b128 v[84:87], v25
    ds_read_b64_tr_b16 v[168:169], v4 offset:2048
    ds_read_b64_tr_b16 v[170:171], v4 offset:2560
    v_mfma_f32_32x32x16_bf16 v[48:63], v[68:71], v[140:143], v[48:63]
    ds_read_b64_tr_b16 v[172:173], v5 offset:2048
    ds_read_b64_tr_b16 v[174:175], v5 offset:2560
    v_mfma_f32_32x32x16_bf16 v[32:47], v[72:75], v[144:147], v[32:47]
    v_add_u32 v25, 108544, v19
    ds_read_b128 v[88:91], v25
    ds_read_b64_tr_b16 v[176:177], v4 offset:4096
    ds_read_b64_tr_b16 v[178:179], v4 offset:4608
    v_mfma_f32_32x32x16_bf16 v[48:63], v[72:75], v[148:151], v[48:63]
    ds_read_b64_tr_b16 v[180:181], v5 offset:4096
    ds_read_b64_tr_b16 v[182:183], v5 offset:4608
    v_mfma_f32_32x32x16_bf16 v[32:47], v[76:79], v[152:155], v[32:47]
    v_add_u32 v25, 108544, v20
    ds_read_b128 v[92:95], v25
    ds_read_b64_tr_b16 v[184:185], v4 offset:6144
    ds_read_b64_tr_b16 v[186:187], v4 offset:6656
    v_mfma_f32_32x32x16_bf16 v[48:63], v[76:79], v[156:159], v[48:63]
    ds_read_b64_tr_b16 v[188:189], v5 offset:6144
    ds_read_b64_tr_b16 v[190:191], v5 offset:6656
    s_waitcnt vmcnt(15) lgkmcnt(0)
    s_barrier
    s_add_u32 s40, s39, 0
    s_mov_b32 m0, s40
    s_mov_b32 s41, 1441792
    buffer_load_dwordx4 v3, s[16:19], s41 offen lds
    s_add_u32 s40, s39, 1024
    s_mov_b32 m0, s40
    s_mov_b32 s41, 1449984
    buffer_load_dwordx4 v3, s[16:19], s41 offen lds
    s_add_u32 s40, s47, 74752
    s_mov_b32 m0, s40
    s_mov_b32 s42, 896
    buffer_load_dwordx4 v2, s[12:15], s42 offen lds
    s_add_u32 s40, s47, 75776
    s_mov_b32 m0, s40
    s_mov_b32 s42, 17280
    buffer_load_dwordx4 v16, s[12:15], s42 offen lds
    s_add_u32 s40, s47, 76800
    s_mov_b32 m0, s40
    s_mov_b32 s42, 33664
    buffer_load_dwordx4 v2, s[12:15], s42 offen lds
    s_add_u32 s40, s47, 77824
    s_mov_b32 m0, s40
    s_mov_b32 s42, 50048
    buffer_load_dwordx4 v16, s[12:15], s42 offen lds
    v_mfma_f32_32x32x16_bf16 v[32:47], v[80:83], v[160:163], v[32:47]
    v_add_u32 v25, 125952, v17
    ds_read_b128 v[64:67], v25
    ds_read_b64_tr_b16 v[128:129], v4 offset:8192
    ds_read_b64_tr_b16 v[130:131], v4 offset:8704
    v_mfma_f32_32x32x16_bf16 v[48:63], v[80:83], v[164:167], v[48:63]
    ds_read_b64_tr_b16 v[132:133], v5 offset:8192
    ds_read_b64_tr_b16 v[134:135], v5 offset:8704
    v_mfma_f32_32x32x16_bf16 v[32:47], v[84:87], v[168:171], v[32:47]
    v_add_u32 v25, 125952, v18
    ds_read_b128 v[68:71], v25
    ds_read_b64_tr_b16 v[136:137], v4 offset:10240
    ds_read_b64_tr_b16 v[138:139], v4 offset:10752
    v_mfma_f32_32x32x16_bf16 v[48:63], v[84:87], v[172:175], v[48:63]
    ds_read_b64_tr_b16 v[140:141], v5 offset:10240
    ds_read_b64_tr_b16 v[142:143], v5 offset:10752
    v_mfma_f32_32x32x16_bf16 v[32:47], v[88:91], v[176:179], v[32:47]
    v_add_u32 v25, 125952, v19
    ds_read_b128 v[72:75], v25
    ds_read_b64_tr_b16 v[144:145], v4 offset:12288
    ds_read_b64_tr_b16 v[146:147], v4 offset:12800
    v_mfma_f32_32x32x16_bf16 v[48:63], v[88:91], v[180:183], v[48:63]
    ds_read_b64_tr_b16 v[148:149], v5 offset:12288
    ds_read_b64_tr_b16 v[150:151], v5 offset:12800
    v_mfma_f32_32x32x16_bf16 v[32:47], v[92:95], v[184:187], v[32:47]
    v_add_u32 v25, 125952, v20
    ds_read_b128 v[76:79], v25
    ds_read_b64_tr_b16 v[152:153], v4 offset:14336
    ds_read_b64_tr_b16 v[154:155], v4 offset:14848
    v_mfma_f32_32x32x16_bf16 v[48:63], v[92:95], v[188:191], v[48:63]
    ds_read_b64_tr_b16 v[156:157], v5 offset:14336
    ds_read_b64_tr_b16 v[158:159], v5 offset:14848
    s_waitcnt vmcnt(19) lgkmcnt(0)
    s_barrier
    s_add_u32 s40, s39, 8192
    s_mov_b32 m0, s40
    s_mov_b32 s41, 458752
    buffer_load_dwordx4 v3, s[16:19], s41 offen lds
    s_add_u32 s40, s39, 9216
    s_mov_b32 m0, s40
    s_mov_b32 s41, 466944
    buffer_load_dwordx4 v3, s[16:19], s41 offen lds
    s_add_u32 s40, s47, 92160
    s_mov_b32 m0, s40
    s_mov_b32 s42, 1920
    buffer_load_dwordx4 v2, s[12:15], s42 offen lds
    s_add_u32 s40, s47, 93184
    s_mov_b32 m0, s40
    s_mov_b32 s42, 18304
    buffer_load_dwordx4 v16, s[12:15], s42 offen lds
    s_add_u32 s40, s47, 94208
    s_mov_b32 m0, s40
    s_mov_b32 s42, 34688
    buffer_load_dwordx4 v2, s[12:15], s42 offen lds
    s_add_u32 s40, s47, 95232
    s_mov_b32 m0, s40
    s_mov_b32 s42, 51072
    buffer_load_dwordx4 v16, s[12:15], s42 offen lds
    v_mfma_f32_32x32x16_bf16 v[32:47], v[64:67], v[128:131], v[32:47]
    v_add_u32 v25, 108544, v21
    ds_read_b128 v[80:83], v25
    ds_read_b64_tr_b16 v[160:161], v4 offset:16384
    ds_read_b64_tr_b16 v[162:163], v4 offset:16896
    v_mfma_f32_32x32x16_bf16 v[48:63], v[64:67], v[132:135], v[48:63]
    ds_read_b64_tr_b16 v[164:165], v5 offset:16384
    ds_read_b64_tr_b16 v[166:167], v5 offset:16896
    v_mfma_f32_32x32x16_bf16 v[32:47], v[68:71], v[136:139], v[32:47]
    v_add_u32 v25, 108544, v22
    ds_read_b128 v[84:87], v25
    ds_read_b64_tr_b16 v[168:169], v4 offset:18432
    ds_read_b64_tr_b16 v[170:171], v4 offset:18944
    v_mfma_f32_32x32x16_bf16 v[48:63], v[68:71], v[140:143], v[48:63]
    ds_read_b64_tr_b16 v[172:173], v5 offset:18432
    ds_read_b64_tr_b16 v[174:175], v5 offset:18944
    v_mfma_f32_32x32x16_bf16 v[32:47], v[72:75], v[144:147], v[32:47]
    v_add_u32 v25, 108544, v23
    ds_read_b128 v[88:91], v25
    ds_read_b64_tr_b16 v[176:177], v4 offset:20480
    ds_read_b64_tr_b16 v[178:179], v4 offset:20992
    v_mfma_f32_32x32x16_bf16 v[48:63], v[72:75], v[148:151], v[48:63]
    ds_read_b64_tr_b16 v[180:181], v5 offset:20480
    ds_read_b64_tr_b16 v[182:183], v5 offset:20992
    v_mfma_f32_32x32x16_bf16 v[32:47], v[76:79], v[152:155], v[32:47]
    v_add_u32 v25, 108544, v24
    ds_read_b128 v[92:95], v25
    ds_read_b64_tr_b16 v[184:185], v4 offset:22528
    ds_read_b64_tr_b16 v[186:187], v4 offset:23040
    v_mfma_f32_32x32x16_bf16 v[48:63], v[76:79], v[156:159], v[48:63]
    ds_read_b64_tr_b16 v[188:189], v5 offset:22528
    ds_read_b64_tr_b16 v[190:191], v5 offset:23040
    s_waitcnt vmcnt(12) lgkmcnt(0)
    s_barrier
    s_add_u32 s40, s39, 16384
    s_mov_b32 m0, s40
    s_mov_b32 s41, 983040
    buffer_load_dwordx4 v3, s[16:19], s41 offen lds
    s_add_u32 s40, s39, 17408
    s_mov_b32 m0, s40
    s_mov_b32 s41, 991232
    buffer_load_dwordx4 v3, s[16:19], s41 offen lds
    s_mov_b32 m0, 91136
    s_add_u32 s42, s56, 896
    buffer_load_dwordx4 v2, s[12:15], s42 offen lds
    v_mfma_f32_32x32x16_bf16 v[32:47], v[80:83], v[160:163], v[32:47]
    v_add_u32 v25, 40960, v17
    ds_read_b128 v[64:67], v25
    ds_read_b64_tr_b16 v[128:129], v4 offset:24576
    ds_read_b64_tr_b16 v[130:131], v4 offset:25088
    v_mfma_f32_32x32x16_bf16 v[48:63], v[80:83], v[164:167], v[48:63]
    ds_read_b64_tr_b16 v[132:133], v5 offset:24576
    ds_read_b64_tr_b16 v[134:135], v5 offset:25088
    v_mfma_f32_32x32x16_bf16 v[32:47], v[84:87], v[168:171], v[32:47]
    v_add_u32 v25, 40960, v18
    ds_read_b128 v[68:71], v25
    ds_read_b64_tr_b16 v[136:137], v4 offset:26624
    ds_read_b64_tr_b16 v[138:139], v4 offset:27136
    v_mfma_f32_32x32x16_bf16 v[48:63], v[84:87], v[172:175], v[48:63]
    ds_read_b64_tr_b16 v[140:141], v5 offset:26624
    ds_read_b64_tr_b16 v[142:143], v5 offset:27136
    v_mfma_f32_32x32x16_bf16 v[32:47], v[88:91], v[176:179], v[32:47]
    v_add_u32 v25, 40960, v19
    ds_read_b128 v[72:75], v25
    ds_read_b64_tr_b16 v[144:145], v4 offset:28672
    ds_read_b64_tr_b16 v[146:147], v4 offset:29184
    v_mfma_f32_32x32x16_bf16 v[48:63], v[88:91], v[180:183], v[48:63]
    ds_read_b64_tr_b16 v[148:149], v5 offset:28672
    ds_read_b64_tr_b16 v[150:151], v5 offset:29184
    v_mfma_f32_32x32x16_bf16 v[32:47], v[92:95], v[184:187], v[32:47]
    v_add_u32 v25, 40960, v20
    ds_read_b128 v[76:79], v25
    ds_read_b64_tr_b16 v[152:153], v4 offset:30720
    ds_read_b64_tr_b16 v[154:155], v4 offset:31232
    v_mfma_f32_32x32x16_bf16 v[48:63], v[92:95], v[188:191], v[48:63]
    ds_read_b64_tr_b16 v[156:157], v5 offset:30720
    ds_read_b64_tr_b16 v[158:159], v5 offset:31232
    s_waitcnt vmcnt(15) lgkmcnt(0)
    s_barrier
    s_add_u32 s40, s39, 24576
    s_mov_b32 m0, s40
    s_mov_b32 s41, 1507328
    buffer_load_dwordx4 v3, s[16:19], s41 offen lds
    s_add_u32 s40, s39, 25600
    s_mov_b32 m0, s40
    s_mov_b32 s41, 1515520
    buffer_load_dwordx4 v3, s[16:19], s41 offen lds
    v_mfma_f32_32x32x16_bf16 v[32:47], v[64:67], v[128:131], v[32:47]
    v_add_u32 v25, 58368, v17
    ds_read_b128 v[80:83], v25
    ds_read_b64_tr_b16 v[160:161], v4 offset:32768
    ds_read_b64_tr_b16 v[162:163], v4 offset:33280
    v_mfma_f32_32x32x16_bf16 v[48:63], v[64:67], v[132:135], v[48:63]
    ds_read_b64_tr_b16 v[164:165], v5 offset:32768
    ds_read_b64_tr_b16 v[166:167], v5 offset:33280
    v_mfma_f32_32x32x16_bf16 v[32:47], v[68:71], v[136:139], v[32:47]
    v_add_u32 v25, 58368, v18
    ds_read_b128 v[84:87], v25
    ds_read_b64_tr_b16 v[168:169], v4 offset:34816
    ds_read_b64_tr_b16 v[170:171], v4 offset:35328
    v_mfma_f32_32x32x16_bf16 v[48:63], v[68:71], v[140:143], v[48:63]
    ds_read_b64_tr_b16 v[172:173], v5 offset:34816
    ds_read_b64_tr_b16 v[174:175], v5 offset:35328
    v_mfma_f32_32x32x16_bf16 v[32:47], v[72:75], v[144:147], v[32:47]
    v_add_u32 v25, 58368, v19
    ds_read_b128 v[88:91], v25
    ds_read_b64_tr_b16 v[176:177], v4 offset:36864
    ds_read_b64_tr_b16 v[178:179], v4 offset:37376
    v_mfma_f32_32x32x16_bf16 v[48:63], v[72:75], v[148:151], v[48:63]
    ds_read_b64_tr_b16 v[180:181], v5 offset:36864
    ds_read_b64_tr_b16 v[182:183], v5 offset:37376
    v_mfma_f32_32x32x16_bf16 v[32:47], v[76:79], v[152:155], v[32:47]
    v_add_u32 v25, 58368, v20
    ds_read_b128 v[92:95], v25
    ds_read_b64_tr_b16 v[184:185], v4 offset:38912
    ds_read_b64_tr_b16 v[186:187], v4 offset:39424
    v_mfma_f32_32x32x16_bf16 v[48:63], v[76:79], v[156:159], v[48:63]
    ds_read_b64_tr_b16 v[188:189], v5 offset:38912
    ds_read_b64_tr_b16 v[190:191], v5 offset:39424
    s_waitcnt vmcnt(15) lgkmcnt(0)
    s_barrier
    v_mfma_f32_32x32x16_bf16 v[32:47], v[80:83], v[160:163], v[32:47]
    v_add_u32 v25, 40960, v21
    ds_read_b128 v[64:67], v25
    ds_read_b64_tr_b16 v[128:129], v4 offset:0
    ds_read_b64_tr_b16 v[130:131], v4 offset:512
    v_mfma_f32_32x32x16_bf16 v[48:63], v[80:83], v[164:167], v[48:63]
    ds_read_b64_tr_b16 v[132:133], v5 offset:0
    ds_read_b64_tr_b16 v[134:135], v5 offset:512
    v_mfma_f32_32x32x16_bf16 v[32:47], v[84:87], v[168:171], v[32:47]
    v_add_u32 v25, 40960, v22
    ds_read_b128 v[68:71], v25
    ds_read_b64_tr_b16 v[136:137], v4 offset:2048
    ds_read_b64_tr_b16 v[138:139], v4 offset:2560
    v_mfma_f32_32x32x16_bf16 v[48:63], v[84:87], v[172:175], v[48:63]
    ds_read_b64_tr_b16 v[140:141], v5 offset:2048
    ds_read_b64_tr_b16 v[142:143], v5 offset:2560
    v_mfma_f32_32x32x16_bf16 v[32:47], v[88:91], v[176:179], v[32:47]
    v_add_u32 v25, 40960, v23
    ds_read_b128 v[72:75], v25
    ds_read_b64_tr_b16 v[144:145], v4 offset:4096
    ds_read_b64_tr_b16 v[146:147], v4 offset:4608
    v_mfma_f32_32x32x16_bf16 v[48:63], v[88:91], v[180:183], v[48:63]
    ds_read_b64_tr_b16 v[148:149], v5 offset:4096
    ds_read_b64_tr_b16 v[150:151], v5 offset:4608
    v_mfma_f32_32x32x16_bf16 v[32:47], v[92:95], v[184:187], v[32:47]
    v_add_u32 v25, 40960, v24
    ds_read_b128 v[76:79], v25
    ds_read_b64_tr_b16 v[152:153], v4 offset:6144
    ds_read_b64_tr_b16 v[154:155], v4 offset:6656
    v_mfma_f32_32x32x16_bf16 v[48:63], v[92:95], v[188:191], v[48:63]
    ds_read_b64_tr_b16 v[156:157], v5 offset:6144
    ds_read_b64_tr_b16 v[158:159], v5 offset:6656
    s_waitcnt vmcnt(2) lgkmcnt(0)
    s_barrier
    v_mfma_f32_32x32x16_bf16 v[32:47], v[64:67], v[128:131], v[32:47]
    v_add_u32 v25, 74752, v17
    ds_read_b128 v[80:83], v25
    ds_read_b64_tr_b16 v[160:161], v4 offset:8192
    ds_read_b64_tr_b16 v[162:163], v4 offset:8704
    v_mfma_f32_32x32x16_bf16 v[48:63], v[64:67], v[132:135], v[48:63]
    ds_read_b64_tr_b16 v[164:165], v5 offset:8192
    ds_read_b64_tr_b16 v[166:167], v5 offset:8704
    v_mfma_f32_32x32x16_bf16 v[32:47], v[68:71], v[136:139], v[32:47]
    v_add_u32 v25, 74752, v18
    ds_read_b128 v[84:87], v25
    ds_read_b64_tr_b16 v[168:169], v4 offset:10240
    ds_read_b64_tr_b16 v[170:171], v4 offset:10752
    v_mfma_f32_32x32x16_bf16 v[48:63], v[68:71], v[140:143], v[48:63]
    ds_read_b64_tr_b16 v[172:173], v5 offset:10240
    ds_read_b64_tr_b16 v[174:175], v5 offset:10752
    v_mfma_f32_32x32x16_bf16 v[32:47], v[72:75], v[144:147], v[32:47]
    v_add_u32 v25, 74752, v19
    ds_read_b128 v[88:91], v25
    ds_read_b64_tr_b16 v[176:177], v4 offset:12288
    ds_read_b64_tr_b16 v[178:179], v4 offset:12800
    v_mfma_f32_32x32x16_bf16 v[48:63], v[72:75], v[148:151], v[48:63]
    ds_read_b64_tr_b16 v[180:181], v5 offset:12288
    ds_read_b64_tr_b16 v[182:183], v5 offset:12800
    v_mfma_f32_32x32x16_bf16 v[32:47], v[76:79], v[152:155], v[32:47]
    v_add_u32 v25, 74752, v20
    ds_read_b128 v[92:95], v25
    ds_read_b64_tr_b16 v[184:185], v4 offset:14336
    ds_read_b64_tr_b16 v[186:187], v4 offset:14848
    v_mfma_f32_32x32x16_bf16 v[48:63], v[76:79], v[156:159], v[48:63]
    ds_read_b64_tr_b16 v[188:189], v5 offset:14336
    ds_read_b64_tr_b16 v[190:191], v5 offset:14848
    s_waitcnt vmcnt(2) lgkmcnt(0)
    s_barrier
    v_mfma_f32_32x32x16_bf16 v[32:47], v[80:83], v[160:163], v[32:47]
    v_add_u32 v25, 92160, v17
    ds_read_b128 v[64:67], v25
    ds_read_b64_tr_b16 v[128:129], v4 offset:16384
    ds_read_b64_tr_b16 v[130:131], v4 offset:16896
    v_mfma_f32_32x32x16_bf16 v[48:63], v[80:83], v[164:167], v[48:63]
    ds_read_b64_tr_b16 v[132:133], v5 offset:16384
    ds_read_b64_tr_b16 v[134:135], v5 offset:16896
    v_mfma_f32_32x32x16_bf16 v[32:47], v[84:87], v[168:171], v[32:47]
    v_add_u32 v25, 92160, v18
    ds_read_b128 v[68:71], v25
    ds_read_b64_tr_b16 v[136:137], v4 offset:18432
    ds_read_b64_tr_b16 v[138:139], v4 offset:18944
    v_mfma_f32_32x32x16_bf16 v[48:63], v[84:87], v[172:175], v[48:63]
    ds_read_b64_tr_b16 v[140:141], v5 offset:18432
    ds_read_b64_tr_b16 v[142:143], v5 offset:18944
    v_mfma_f32_32x32x16_bf16 v[32:47], v[88:91], v[176:179], v[32:47]
    v_add_u32 v25, 92160, v19
    ds_read_b128 v[72:75], v25
    ds_read_b64_tr_b16 v[144:145], v4 offset:20480
    ds_read_b64_tr_b16 v[146:147], v4 offset:20992
    v_mfma_f32_32x32x16_bf16 v[48:63], v[88:91], v[180:183], v[48:63]
    ds_read_b64_tr_b16 v[148:149], v5 offset:20480
    ds_read_b64_tr_b16 v[150:151], v5 offset:20992
    v_mfma_f32_32x32x16_bf16 v[32:47], v[92:95], v[184:187], v[32:47]
    v_add_u32 v25, 92160, v20
    ds_read_b128 v[76:79], v25
    ds_read_b64_tr_b16 v[152:153], v4 offset:22528
    ds_read_b64_tr_b16 v[154:155], v4 offset:23040
    v_mfma_f32_32x32x16_bf16 v[48:63], v[92:95], v[188:191], v[48:63]
    ds_read_b64_tr_b16 v[156:157], v5 offset:22528
    ds_read_b64_tr_b16 v[158:159], v5 offset:23040
    s_waitcnt vmcnt(0) lgkmcnt(0)
    s_barrier
    v_mfma_f32_32x32x16_bf16 v[32:47], v[64:67], v[128:131], v[32:47]
    v_add_u32 v25, 74752, v21
    ds_read_b128 v[80:83], v25
    ds_read_b64_tr_b16 v[160:161], v4 offset:24576
    ds_read_b64_tr_b16 v[162:163], v4 offset:25088
    v_mfma_f32_32x32x16_bf16 v[48:63], v[64:67], v[132:135], v[48:63]
    ds_read_b64_tr_b16 v[164:165], v5 offset:24576
    ds_read_b64_tr_b16 v[166:167], v5 offset:25088
    v_mfma_f32_32x32x16_bf16 v[32:47], v[68:71], v[136:139], v[32:47]
    v_add_u32 v25, 74752, v22
    ds_read_b128 v[84:87], v25
    ds_read_b64_tr_b16 v[168:169], v4 offset:26624
    ds_read_b64_tr_b16 v[170:171], v4 offset:27136
    v_mfma_f32_32x32x16_bf16 v[48:63], v[68:71], v[140:143], v[48:63]
    ds_read_b64_tr_b16 v[172:173], v5 offset:26624
    ds_read_b64_tr_b16 v[174:175], v5 offset:27136
    v_mfma_f32_32x32x16_bf16 v[32:47], v[72:75], v[144:147], v[32:47]
    v_add_u32 v25, 74752, v23
    ds_read_b128 v[88:91], v25
    ds_read_b64_tr_b16 v[176:177], v4 offset:28672
    ds_read_b64_tr_b16 v[178:179], v4 offset:29184
    v_mfma_f32_32x32x16_bf16 v[48:63], v[72:75], v[148:151], v[48:63]
    ds_read_b64_tr_b16 v[180:181], v5 offset:28672
    ds_read_b64_tr_b16 v[182:183], v5 offset:29184
    v_mfma_f32_32x32x16_bf16 v[32:47], v[76:79], v[152:155], v[32:47]
    v_add_u32 v25, 74752, v24
    ds_read_b128 v[92:95], v25
    ds_read_b64_tr_b16 v[184:185], v4 offset:30720
    ds_read_b64_tr_b16 v[186:187], v4 offset:31232
    v_mfma_f32_32x32x16_bf16 v[48:63], v[76:79], v[156:159], v[48:63]
    ds_read_b64_tr_b16 v[188:189], v5 offset:30720
    ds_read_b64_tr_b16 v[190:191], v5 offset:31232
    s_waitcnt lgkmcnt(0)
    s_barrier
    v_mfma_f32_32x32x16_bf16 v[32:47], v[80:83], v[160:163], v[32:47]
    v_mfma_f32_32x32x16_bf16 v[48:63], v[80:83], v[164:167], v[48:63]
    v_mfma_f32_32x32x16_bf16 v[32:47], v[84:87], v[168:171], v[32:47]
    v_mfma_f32_32x32x16_bf16 v[48:63], v[84:87], v[172:175], v[48:63]
    v_mfma_f32_32x32x16_bf16 v[32:47], v[88:91], v[176:179], v[32:47]
    v_mfma_f32_32x32x16_bf16 v[48:63], v[88:91], v[180:183], v[48:63]
    v_mfma_f32_32x32x16_bf16 v[32:47], v[92:95], v[184:187], v[32:47]
    v_mfma_f32_32x32x16_bf16 v[48:63], v[92:95], v[188:191], v[48:63]
    s_waitcnt vmcnt(0) lgkmcnt(0)
    s_barrier
    s_nop 7
    s_nop 7
    v_lshlrev_b32 v6, 16, v6
    v_lshlrev_b32 v7, 16, v7
    v_add_f32 v32, v32, v6
    v_add_f32 v33, v33, v6
    v_add_f32 v34, v34, v6
    v_add_f32 v35, v35, v6
    v_add_f32 v36, v36, v6
    v_add_f32 v37, v37, v6
    v_add_f32 v38, v38, v6
    v_add_f32 v39, v39, v6
    v_add_f32 v40, v40, v6
    v_add_f32 v41, v41, v6
    v_add_f32 v42, v42, v6
    v_add_f32 v43, v43, v6
    v_add_f32 v44, v44, v6
    v_add_f32 v45, v45, v6
    v_add_f32 v46, v46, v6
    v_add_f32 v47, v47, v6
    v_add_f32 v48, v48, v7
    v_add_f32 v49, v49, v7
    v_add_f32 v50, v50, v7
    v_add_f32 v51, v51, v7
    v_add_f32 v52, v52, v7
    v_add_f32 v53, v53, v7
    v_add_f32 v54, v54, v7
    v_add_f32 v55, v55, v7
    v_add_f32 v56, v56, v7
    v_add_f32 v57, v57, v7
    v_add_f32 v58, v58, v7
    v_add_f32 v59, v59, v7
    v_add_f32 v60, v60, v7
    v_add_f32 v61, v61, v7
    v_add_f32 v62, v62, v7
    v_add_f32 v63, v63, v7
    v_lshrrev_b32 v24, 5, v1
    v_lshlrev_b32 v24, 2, v24
    v_add_u32 v24, s34, v24
    v_add_u32 v25, 0, v24
    v_add_u32 v25, 1, v24
    v_add_u32 v25, 2, v24
    v_add_u32 v25, 3, v24
    v_add_u32 v25, 8, v24
    v_add_u32 v25, 9, v24
    v_add_u32 v25, 10, v24
    v_add_u32 v25, 11, v24
    v_add_u32 v25, 16, v24
    v_add_u32 v25, 17, v24
    v_add_u32 v25, 18, v24
    v_add_u32 v25, 19, v24
    v_add_u32 v25, 24, v24
    v_add_u32 v25, 25, v24
    v_add_u32 v25, 26, v24
    v_add_u32 v25, 27, v24
    s_mov_b32 s43, 1999
    v_add_u32 v25, 0, v24
    v_cmp_gt_u32 vcc, s43, v25
    s_nop 1
    v_cndmask_b32 v8, 0, 1.0, vcc
    v_add_u32 v25, 1, v24
    v_cmp_gt_u32 vcc, s43, v25
    s_nop 1
    v_cndmask_b32 v9, 0, 1.0, vcc
    v_add_u32 v25, 2, v24
    v_cmp_gt_u32 vcc, s43, v25
    s_nop 1
    v_cndmask_b32 v10, 0, 1.0, vcc
    v_add_u32 v25, 3, v24
    v_cmp_gt_u32 vcc, s43, v25
    s_nop 1
    v_cndmask_b32 v11, 0, 1.0, vcc
    v_add_u32 v25, 8, v24
    v_cmp_gt_u32 vcc, s43, v25
    s_nop 1
    v_cndmask_b32 v12, 0, 1.0, vcc
    v_add_u32 v25, 9, v24
    v_cmp_gt_u32 vcc, s43, v25
    s_nop 1
    v_cndmask_b32 v13, 0, 1.0, vcc
    v_add_u32 v25, 10, v24
    v_cmp_gt_u32 vcc, s43, v25
    s_nop 1
    v_cndmask_b32 v14, 0, 1.0, vcc
    v_add_u32 v25, 11, v24
    v_cmp_gt_u32 vcc, s43, v25
    s_nop 1
    v_cndmask_b32 v15, 0, 1.0, vcc
    v_add_u32 v25, 16, v24
    v_cmp_gt_u32 vcc, s43, v25
    s_nop 1
    v_cndmask_b32 v16, 0, 1.0, vcc
    v_add_u32 v25, 17, v24
    v_cmp_gt_u32 vcc, s43, v25
    s_nop 1
    v_cndmask_b32 v17, 0, 1.0, vcc
    v_add_u32 v25, 18, v24
    v_cmp_gt_u32 vcc, s43, v25
    s_nop 1
    v_cndmask_b32 v18, 0, 1.0, vcc
    v_add_u32 v25, 19, v24
    v_cmp_gt_u32 vcc, s43, v25
    s_nop 1
    v_cndmask_b32 v19, 0, 1.0, vcc
    v_add_u32 v25, 24, v24
    v_cmp_gt_u32 vcc, s43, v25
    s_nop 1
    v_cndmask_b32 v20, 0, 1.0, vcc
    v_add_u32 v25, 25, v24
    v_cmp_gt_u32 vcc, s43, v25
    s_nop 1
    v_cndmask_b32 v21, 0, 1.0, vcc
    v_add_u32 v25, 26, v24
    v_cmp_gt_u32 vcc, s43, v25
    s_nop 1
    v_cndmask_b32 v22, 0, 1.0, vcc
    v_add_u32 v25, 27, v24
    v_cmp_gt_u32 vcc, s43, v25
    s_nop 1
    v_cndmask_b32 v23, 0, 1.0, vcc
    v_mov_b32 v26, 0
    v_fmac_f32 v26, v32, v8
    v_fmac_f32 v26, v33, v9
    v_fmac_f32 v26, v34, v10
    v_fmac_f32 v26, v35, v11
    v_fmac_f32 v26, v36, v12
    v_fmac_f32 v26, v37, v13
    v_fmac_f32 v26, v38, v14
    v_fmac_f32 v26, v39, v15
    v_fmac_f32 v26, v40, v16
    v_fmac_f32 v26, v41, v17
    v_fmac_f32 v26, v42, v18
    v_fmac_f32 v26, v43, v19
    v_fmac_f32 v26, v44, v20
    v_fmac_f32 v26, v45, v21
    v_fmac_f32 v26, v46, v22
    v_fmac_f32 v26, v47, v23
    v_mov_b32 v27, 0
    v_fmac_f32 v27, v48, v8
    v_fmac_f32 v27, v49, v9
    v_fmac_f32 v27, v50, v10
    v_fmac_f32 v27, v51, v11
    v_fmac_f32 v27, v52, v12
    v_fmac_f32 v27, v53, v13
    v_fmac_f32 v27, v54, v14
    v_fmac_f32 v27, v55, v15
    v_fmac_f32 v27, v56, v16
    v_fmac_f32 v27, v57, v17
    v_fmac_f32 v27, v58, v18
    v_fmac_f32 v27, v59, v19
    v_fmac_f32 v27, v60, v20
    v_fmac_f32 v27, v61, v21
    v_fmac_f32 v27, v62, v22
    v_fmac_f32 v27, v63, v23
    v_mov_b32 v28, v26
    s_nop 1
    v_permlane32_swap_b32 v26, v28
    s_nop 1
    v_add_f32 v26, v26, v28
    v_mov_b32 v28, v27
    s_nop 1
    v_permlane32_swap_b32 v27, v28
    s_nop 1
    v_add_f32 v27, v27, v28
    s_sub_i32 s44, 1999, s34
    s_max_i32 s44, s44, 0
    s_min_i32 s44, s44, 32
    s_max_i32 s45, s44, 1
    v_cvt_f32_u32 v29, s45
    v_rcp_f32 v29, v29
    s_nop 0
    v_mul_f32 v30, v26, v29
    v_mul_f32 v31, v27, v29
    v_mov_b32 v64, 0
    v_sub_f32 v66, v32, v30
    v_mul_f32 v66, v66, v8
    v_fmac_f32 v64, v66, v66
    v_sub_f32 v66, v33, v30
    v_mul_f32 v66, v66, v9
    v_fmac_f32 v64, v66, v66
    v_sub_f32 v66, v34, v30
    v_mul_f32 v66, v66, v10
    v_fmac_f32 v64, v66, v66
    v_sub_f32 v66, v35, v30
    v_mul_f32 v66, v66, v11
    v_fmac_f32 v64, v66, v66
    v_sub_f32 v66, v36, v30
    v_mul_f32 v66, v66, v12
    v_fmac_f32 v64, v66, v66
    v_sub_f32 v66, v37, v30
    v_mul_f32 v66, v66, v13
    v_fmac_f32 v64, v66, v66
    v_sub_f32 v66, v38, v30
    v_mul_f32 v66, v66, v14
    v_fmac_f32 v64, v66, v66
    v_sub_f32 v66, v39, v30
    v_mul_f32 v66, v66, v15
    v_fmac_f32 v64, v66, v66
    v_sub_f32 v66, v40, v30
    v_mul_f32 v66, v66, v16
    v_fmac_f32 v64, v66, v66
    v_sub_f32 v66, v41, v30
    v_mul_f32 v66, v66, v17
    v_fmac_f32 v64, v66, v66
    v_sub_f32 v66, v42, v30
    v_mul_f32 v66, v66, v18
    v_fmac_f32 v64, v66, v66
    v_sub_f32 v66, v43, v30
    v_mul_f32 v66, v66, v19
    v_fmac_f32 v64, v66, v66
    v_sub_f32 v66, v44, v30
    v_mul_f32 v66, v66, v20
    v_fmac_f32 v64, v66, v66
    v_sub_f32 v66, v45, v30
    v_mul_f32 v66, v66, v21
    v_fmac_f32 v64, v66, v66
    v_sub_f32 v66, v46, v30
    v_mul_f32 v66, v66, v22
    v_fmac_f32 v64, v66, v66
    v_sub_f32 v66, v47, v30
    v_mul_f32 v66, v66, v23
    v_fmac_f32 v64, v66, v66
    v_mov_b32 v65, 0
    v_sub_f32 v66, v48, v31
    v_mul_f32 v66, v66, v8
    v_fmac_f32 v65, v66, v66
    v_sub_f32 v66, v49, v31
    v_mul_f32 v66, v66, v9
    v_fmac_f32 v65, v66, v66
    v_sub_f32 v66, v50, v31
    v_mul_f32 v66, v66, v10
    v_fmac_f32 v65, v66, v66
    v_sub_f32 v66, v51, v31
    v_mul_f32 v66, v66, v11
    v_fmac_f32 v65, v66, v66
    v_sub_f32 v66, v52, v31
    v_mul_f32 v66, v66, v12
    v_fmac_f32 v65, v66, v66
    v_sub_f32 v66, v53, v31
    v_mul_f32 v66, v66, v13
    v_fmac_f32 v65, v66, v66
    v_sub_f32 v66, v54, v31
    v_mul_f32 v66, v66, v14
    v_fmac_f32 v65, v66, v66
    v_sub_f32 v66, v55, v31
    v_mul_f32 v66, v66, v15
    v_fmac_f32 v65, v66, v66
    v_sub_f32 v66, v56, v31
    v_mul_f32 v66, v66, v16
    v_fmac_f32 v65, v66, v66
    v_sub_f32 v66, v57, v31
    v_mul_f32 v66, v66, v17
    v_fmac_f32 v65, v66, v66
    v_sub_f32 v66, v58, v31
    v_mul_f32 v66, v66, v18
    v_fmac_f32 v65, v66, v66
    v_sub_f32 v66, v59, v31
    v_mul_f32 v66, v66, v19
    v_fmac_f32 v65, v66, v66
    v_sub_f32 v66, v60, v31
    v_mul_f32 v66, v66, v20
    v_fmac_f32 v65, v66, v66
    v_sub_f32 v66, v61, v31
    v_mul_f32 v66, v66, v21
    v_fmac_f32 v65, v66, v66
    v_sub_f32 v66, v62, v31
    v_mul_f32 v66, v66, v22
    v_fmac_f32 v65, v66, v66
    v_sub_f32 v66, v63, v31
    v_mul_f32 v66, v66, v23
    v_fmac_f32 v65, v66, v66
    v_mov_b32 v28, v64
    s_nop 1
    v_permlane32_swap_b32 v64, v28
    s_nop 1
    v_add_f32 v64, v64, v28
    v_mov_b32 v28, v65
    s_nop 1
    v_permlane32_swap_b32 v65, v28
    s_nop 1
    v_add_f32 v65, v65, v28
    v_cmp_gt_u32 vcc, 32, v1
    s_nop 1
    v_cndmask_b32 v68, v27, v26, vcc
    v_cndmask_b32 v69, v65, v64, vcc
    v_lshlrev_b32 v70, 3, v0
    v_add_u32 v70, 32768, v70
    ds_write_b64 v70, v[68:69]
    s_lshl_b32 s46, s31, 12
    v_lshrrev_b32 v71, 5, v1
    v_lshlrev_b32 v71, 2, v71
    v_lshlrev_b32 v71, 7, v71
    v_and_b32 v72, 31, v1
    v_lshlrev_b32 v72, 1, v72
    v_add_u32 v71, v71, v72
    v_add_u32 v71, s46, v71
    v_cvt_pk_bf16_f32 v73, v32, v33
    ds_write_b16 v71, v73 offset:0
    ds_write_b16_d16_hi v71, v73 offset:128
    v_cvt_pk_bf16_f32 v73, v34, v35
    ds_write_b16 v71, v73 offset:256
    ds_write_b16_d16_hi v71, v73 offset:384
    v_cvt_pk_bf16_f32 v73, v36, v37
    ds_write_b16 v71, v73 offset:1024
    ds_write_b16_d16_hi v71, v73 offset:1152
    v_cvt_pk_bf16_f32 v73, v38, v39
    ds_write_b16 v71, v73 offset:1280
    ds_write_b16_d16_hi v71, v73 offset:1408
    v_cvt_pk_bf16_f32 v73, v40, v41
    ds_write_b16 v71, v73 offset:2048
    ds_write_b16_d16_hi v71, v73 offset:2176
    v_cvt_pk_bf16_f32 v73, v42, v43
    ds_write_b16 v71, v73 offset:2304
    ds_write_b16_d16_hi v71, v73 offset:2432
    v_cvt_pk_bf16_f32 v73, v44, v45
    ds_write_b16 v71, v73 offset:3072
    ds_write_b16_d16_hi v71, v73 offset:3200
    v_cvt_pk_bf16_f32 v73, v46, v47
    ds_write_b16 v71, v73 offset:3328
    ds_write_b16_d16_hi v71, v73 offset:3456
    v_cvt_pk_bf16_f32 v73, v48, v49
    ds_write_b16 v71, v73 offset:64
    ds_write_b16_d16_hi v71, v73 offset:192
    v_cvt_pk_bf16_f32 v73, v50, v51
    ds_write_b16 v71, v73 offset:320
    ds_write_b16_d16_hi v71, v73 offset:448
    v_cvt_pk_bf16_f32 v73, v52, v53
    ds_write_b16 v71, v73 offset:1088
    ds_write_b16_d16_hi v71, v73 offset:1216
    v_cvt_pk_bf16_f32 v73, v54, v55
    ds_write_b16 v71, v73 offset:1344
    ds_write_b16_d16_hi v71, v73 offset:1472
    v_cvt_pk_bf16_f32 v73, v56, v57
    ds_write_b16 v71, v73 offset:2112
    ds_write_b16_d16_hi v71, v73 offset:2240
    v_cvt_pk_bf16_f32 v73, v58, v59
    ds_write_b16 v71, v73 offset:2368
    ds_write_b16_d16_hi v71, v73 offset:2496
    v_cvt_pk_bf16_f32 v73, v60, v61
    ds_write_b16 v71, v73 offset:3136
    ds_write_b16_d16_hi v71, v73 offset:3264
    v_cvt_pk_bf16_f32 v73, v62, v63
    ds_write_b16 v71, v73 offset:3392
    ds_write_b16_d16_hi v71, v73 offset:3520
    s_waitcnt lgkmcnt(0)
    v_lshlrev_b32 v71, 4, v1
    v_add_u32 v71, s46, v71
    ds_read_b128 v[76:79], v71 offset:0
    ds_read_b128 v[80:83], v71 offset:1024
    ds_read_b128 v[84:87], v71 offset:2048
    ds_read_b128 v[88:91], v71 offset:3072
    v_lshrrev_b32 v72, 3, v1
    v_add_u32 v72, s34, v72
    s_mul_i32 s35, s28, 1999
    v_add_u32 v73, s35, v72
    v_lshlrev_b32 v73, 10, v73
    v_and_b32 v74, 7, v1
    v_lshlrev_b32 v74, 4, v74
    v_add_u32 v73, v73, v74
    s_lshl_b32 s35, s32, 1
    v_add_u32 v73, s35, v73
    s_waitcnt lgkmcnt(0)
    v_add_u32 v74, 0, v72
    v_cmp_gt_u32 vcc, s43, v74
    s_and_saveexec_b64 s[48:49], vcc
    buffer_store_dwordx4 v[76:79], v73, s[20:23], 0 offen offset:0
    s_mov_b64 exec, s[48:49]
    v_add_u32 v73, 8192, v73
    v_add_u32 v74, 8, v72
    v_cmp_gt_u32 vcc, s43, v74
    s_and_saveexec_b64 s[48:49], vcc
    buffer_store_dwordx4 v[80:83], v73, s[20:23], 0 offen offset:0
    s_mov_b64 exec, s[48:49]
    v_add_u32 v73, 8192, v73
    v_add_u32 v74, 16, v72
    v_cmp_gt_u32 vcc, s43, v74
    s_and_saveexec_b64 s[48:49], vcc
    buffer_store_dwordx4 v[84:87], v73, s[20:23], 0 offen offset:0
    s_mov_b64 exec, s[48:49]
    v_add_u32 v73, 8192, v73
    v_add_u32 v74, 24, v72
    v_cmp_gt_u32 vcc, s43, v74
    s_and_saveexec_b64 s[48:49], vcc
    buffer_store_dwordx4 v[88:91], v73, s[20:23], 0 offen offset:0
    s_mov_b64 exec, s[48:49]
    s_waitcnt lgkmcnt(0)
    s_barrier
    s_cmp_lg_u32 s31, 0
    s_cbranch_scc1 L_g_done
    v_lshlrev_b32 v70, 3, v1
    v_add_u32 v70, 32768, v70
    ds_read_b64 v[80:81], v70 offset:0
    ds_read_b64 v[82:83], v70 offset:512
    ds_read_b64 v[84:85], v70 offset:1024
    ds_read_b64 v[86:87], v70 offset:1536
    s_sub_i32 s50, 1999, s33
    s_max_i32 s50, s50, 0
    s_min_i32 s50, s50, 32
    s_sub_i32 s51, 1967, s33
    s_max_i32 s51, s51, 0
    s_min_i32 s51, s51, 32
    s_sub_i32 s52, 1935, s33
    s_max_i32 s52, s52, 0
    s_min_i32 s52, s52, 32
    s_sub_i32 s53, 1903, s33
    s_max_i32 s53, s53, 0
    s_min_i32 s53, s53, 32
    s_add_u32 s54, s50, s51
    s_add_u32 s54, s54, s52
    s_add_u32 s54, s54, s53
    v_cvt_f32_u32 v90, s54
    v_rcp_f32 v90, v90
    s_waitcnt lgkmcnt(0)
    v_add_f32 v91, v80, v82
    v_add_f32 v91, v91, v84
    v_add_f32 v91, v91, v86
    v_mul_f32 v92, v91, v90
    v_add_f32 v93, v81, v83
    v_add_f32 v93, v93, v85
    v_add_f32 v93, v93, v87
    s_max_i32 s55, s50, 1
    v_cvt_f32_u32 v94, s55
    v_rcp_f32 v94, v94
    v_cvt_f32_u32 v95, s50
    v_mul_f32 v94, v80, v94
    v_sub_f32 v94, v94, v92
    v_mul_f32 v94, v94, v94
    v_fmac_f32 v93, v95, v94
    s_max_i32 s55, s51, 1
    v_cvt_f32_u32 v94, s55
    v_rcp_f32 v94, v94
    v_cvt_f32_u32 v95, s51
    v_mul_f32 v94, v82, v94
    v_sub_f32 v94, v94, v92
    v_mul_f32 v94, v94, v94
    v_fmac_f32 v93, v95, v94
    s_max_i32 s55, s52, 1
    v_cvt_f32_u32 v94, s55
    v_rcp_f32 v94, v94
    v_cvt_f32_u32 v95, s52
    v_mul_f32 v94, v84, v94
    v_sub_f32 v94, v94, v92
    v_mul_f32 v94, v94, v94
    v_fmac_f32 v93, v95, v94
    s_max_i32 s55, s53, 1
    v_cvt_f32_u32 v94, s55
    v_rcp_f32 v94, v94
    v_cvt_f32_u32 v95, s53
    v_mul_f32 v94, v86, v94
    v_sub_f32 v94, v94, v92
    v_mul_f32 v94, v94, v94
    v_fmac_f32 v93, v95, v94
    s_lshl_b32 s35, s28, 4
    s_add_u32 s35, s35, s29
    s_lshl_b32 s35, s35, 9
    s_add_u32 s35, s35, s32
    s_lshl_b32 s35, s35, 3
    s_add_u32 s35, s35, 4194304
    v_lshlrev_b32 v70, 3, v1
    v_add_u32 v70, s35, v70
    v_mov_b32 v92, v93
    v_mov_b32 v90, v91
    v_mov_b32 v91, v92
    buffer_store_dwordx2 v[90:91], v70, s[20:23], 0 offen
L_g_done:
    s_endpgm
.globl norm_gelu_kernel
.p2align 8
.type norm_gelu_kernel,@function
norm_gelu_kernel:
    s_cmp_ge_u32 s2, 256
    s_cbranch_scc1 L_n_done
    s_load_dwordx4 s[4:7], s[0:1], 24
    s_load_dwordx2 s[8:9], s[0:1], 40
    s_load_dwordx2 s[10:11], s[0:1], 56
    s_and_b32 s34, s2, 7
    s_lshr_b32 s35, s2, 3
    s_lshl_b32 s34, s34, 2
    s_lshr_b32 s29, s35, 3
    s_add_u32 s29, s29, s34
    s_and_b32 s30, s35, 7
    s_lshr_b32 s28, s29, 4
    s_and_b32 s29, s29, 15
    s_lshl_b32 s32, s30, 6
    s_lshl_b32 s33, s29, 7
    s_waitcnt lgkmcnt(0)
    s_mov_b32 s12, s4
    s_and_b32 s13, s5, 0xffff
    s_mov_b32 s14, 1024
    s_mov_b32 s15, 0x00020000
    s_mov_b32 s16, s6
    s_and_b32 s17, s7, 0xffff
    s_mov_b32 s18, 1024
    s_mov_b32 s19, 0x00020000
    s_mov_b32 s20, s10
    s_and_b32 s21, s11, 0xffff
    s_mov_b32 s22, 4325376
    s_mov_b32 s23, 0x00020000
    s_mov_b32 s24, s8
    s_and_b32 s25, s9, 0xffff
    s_mov_b32 s26, 4093952
    s_mov_b32 s27, 0x00020000
    v_lshrrev_b32 v2, 3, v0
    v_add_u32 v2, s33, v2
    s_mul_i32 s35, s28, 1999
    v_add_u32 v3, s35, v2
    v_lshlrev_b32 v3, 10, v3
    v_and_b32 v4, 7, v0
    v_lshlrev_b32 v4, 4, v4
    v_add_u32 v3, v3, v4
    s_lshl_b32 s35, s32, 1
    v_add_u32 v3, s35, v3
    s_mov_b32 s43, 1999
    s_mov_b32 s36, 0
    buffer_load_dwordx4 v[32:35], v3, s[20:23], s36 offen
    s_mov_b32 s36, 32768
    buffer_load_dwordx4 v[36:39], v3, s[20:23], s36 offen
    s_mov_b32 s36, 65536
    buffer_load_dwordx4 v[40:43], v3, s[20:23], s36 offen
    s_mov_b32 s36, 98304
    buffer_load_dwordx4 v[44:47], v3, s[20:23], s36 offen
    v_cmp_gt_u32 vcc, 64, v0
    s_and_saveexec_b64 s[48:49], vcc
    s_cbranch_execz L_n_skip
    s_lshl_b32 s35, s28, 4
    s_lshl_b32 s35, s35, 9
    s_add_u32 s35, s35, s32
    s_lshl_b32 s35, s35, 3
    s_add_u32 s35, s35, 4194304
    v_lshlrev_b32 v5, 3, v0
    v_add_u32 v5, s35, v5
    s_mov_b32 s36, 0
    buffer_load_dwordx2 v[64:65], v5, s[20:23], s36 offen
    s_mov_b32 s36, 4096
    buffer_load_dwordx2 v[66:67], v5, s[20:23], s36 offen
    s_mov_b32 s36, 8192
    buffer_load_dwordx2 v[68:69], v5, s[20:23], s36 offen
    s_mov_b32 s36, 12288
    buffer_load_dwordx2 v[70:71], v5, s[20:23], s36 offen
    s_mov_b32 s36, 16384
    buffer_load_dwordx2 v[72:73], v5, s[20:23], s36 offen
    s_mov_b32 s36, 20480
    buffer_load_dwordx2 v[74:75], v5, s[20:23], s36 offen
    s_mov_b32 s36, 24576
    buffer_load_dwordx2 v[76:77], v5, s[20:23], s36 offen
    s_mov_b32 s36, 28672
    buffer_load_dwordx2 v[78:79], v5, s[20:23], s36 offen
    s_mov_b32 s36, 32768
    buffer_load_dwordx2 v[80:81], v5, s[20:23], s36 offen
    s_mov_b32 s36, 36864
    buffer_load_dwordx2 v[82:83], v5, s[20:23], s36 offen
    s_mov_b32 s36, 40960
    buffer_load_dwordx2 v[84:85], v5, s[20:23], s36 offen
    s_mov_b32 s36, 45056
    buffer_load_dwordx2 v[86:87], v5, s[20:23], s36 offen
    s_mov_b32 s36, 49152
    buffer_load_dwordx2 v[88:89], v5, s[20:23], s36 offen
    s_mov_b32 s36, 53248
    buffer_load_dwordx2 v[90:91], v5, s[20:23], s36 offen
    s_mov_b32 s36, 57344
    buffer_load_dwordx2 v[92:93], v5, s[20:23], s36 offen
    s_mov_b32 s36, 61440
    buffer_load_dwordx2 v[94:95], v5, s[20:23], s36 offen
    v_lshlrev_b32 v6, 1, v0
    s_lshl_b32 s35, s32, 1
    v_add_u32 v6, s35, v6
    buffer_load_ushort v7, v6, s[12:15], 0 offen
    buffer_load_ushort v8, v6, s[16:19], 0 offen
    s_waitcnt vmcnt(0)
    v_lshlrev_b32 v7, 16, v7
    v_lshlrev_b32 v8, 16, v8
    v_mov_b32 v9, 0
    v_mov_b32 v10, 0
    v_add_f32 v9, v9, v64
    v_add_f32 v10, v10, v65
    v_add_f32 v9, v9, v66
    v_add_f32 v10, v10, v67
    v_add_f32 v9, v9, v68
    v_add_f32 v10, v10, v69
    v_add_f32 v9, v9, v70
    v_add_f32 v10, v10, v71
    v_add_f32 v9, v9, v72
    v_add_f32 v10, v10, v73
    v_add_f32 v9, v9, v74
    v_add_f32 v10, v10, v75
    v_add_f32 v9, v9, v76
    v_add_f32 v10, v10, v77
    v_add_f32 v9, v9, v78
    v_add_f32 v10, v10, v79
    v_add_f32 v9, v9, v80
    v_add_f32 v10, v10, v81
    v_add_f32 v9, v9, v82
    v_add_f32 v10, v10, v83
    v_add_f32 v9, v9, v84
    v_add_f32 v10, v10, v85
    v_add_f32 v9, v9, v86
    v_add_f32 v10, v10, v87
    v_add_f32 v9, v9, v88
    v_add_f32 v10, v10, v89
    v_add_f32 v9, v9, v90
    v_add_f32 v10, v10, v91
    v_add_f32 v9, v9, v92
    v_add_f32 v10, v10, v93
    v_add_f32 v9, v9, v94
    v_add_f32 v10, v10, v95
    s_mov_b32 s36, 0x3a032338
    v_mul_f32 v11, s36, v9
    s_mov_b32 s37, 0x3c000000
    v_mul_f32 v12, s37, v64
    v_sub_f32 v12, v12, v11
    v_mul_f32 v12, v12, v12
    s_mov_b32 s37, 0x43000000
    v_fmac_f32 v10, s37, v12
    s_mov_b32 s37, 0x3c000000
    v_mul_f32 v12, s37, v66
    v_sub_f32 v12, v12, v11
    v_mul_f32 v12, v12, v12
    s_mov_b32 s37, 0x43000000
    v_fmac_f32 v10, s37, v12
    s_mov_b32 s37, 0x3c000000
    v_mul_f32 v12, s37, v68
    v_sub_f32 v12, v12, v11
    v_mul_f32 v12, v12, v12
    s_mov_b32 s37, 0x43000000
    v_fmac_f32 v10, s37, v12
    s_mov_b32 s37, 0x3c000000
    v_mul_f32 v12, s37, v70
    v_sub_f32 v12, v12, v11
    v_mul_f32 v12, v12, v12
    s_mov_b32 s37, 0x43000000
    v_fmac_f32 v10, s37, v12
    s_mov_b32 s37, 0x3c000000
    v_mul_f32 v12, s37, v72
    v_sub_f32 v12, v12, v11
    v_mul_f32 v12, v12, v12
    s_mov_b32 s37, 0x43000000
    v_fmac_f32 v10, s37, v12
    s_mov_b32 s37, 0x3c000000
    v_mul_f32 v12, s37, v74
    v_sub_f32 v12, v12, v11
    v_mul_f32 v12, v12, v12
    s_mov_b32 s37, 0x43000000
    v_fmac_f32 v10, s37, v12
    s_mov_b32 s37, 0x3c000000
    v_mul_f32 v12, s37, v76
    v_sub_f32 v12, v12, v11
    v_mul_f32 v12, v12, v12
    s_mov_b32 s37, 0x43000000
    v_fmac_f32 v10, s37, v12
    s_mov_b32 s37, 0x3c000000
    v_mul_f32 v12, s37, v78
    v_sub_f32 v12, v12, v11
    v_mul_f32 v12, v12, v12
    s_mov_b32 s37, 0x43000000
    v_fmac_f32 v10, s37, v12
    s_mov_b32 s37, 0x3c000000
    v_mul_f32 v12, s37, v80
    v_sub_f32 v12, v12, v11
    v_mul_f32 v12, v12, v12
    s_mov_b32 s37, 0x43000000
    v_fmac_f32 v10, s37, v12
    s_mov_b32 s37, 0x3c000000
    v_mul_f32 v12, s37, v82
    v_sub_f32 v12, v12, v11
    v_mul_f32 v12, v12, v12
    s_mov_b32 s37, 0x43000000
    v_fmac_f32 v10, s37, v12
    s_mov_b32 s37, 0x3c000000
    v_mul_f32 v12, s37, v84
    v_sub_f32 v12, v12, v11
    v_mul_f32 v12, v12, v12
    s_mov_b32 s37, 0x43000000
    v_fmac_f32 v10, s37, v12
    s_mov_b32 s37, 0x3c000000
    v_mul_f32 v12, s37, v86
    v_sub_f32 v12, v12, v11
    v_mul_f32 v12, v12, v12
    s_mov_b32 s37, 0x43000000
    v_fmac_f32 v10, s37, v12
    s_mov_b32 s37, 0x3c000000
    v_mul_f32 v12, s37, v88
    v_sub_f32 v12, v12, v11
    v_mul_f32 v12, v12, v12
    s_mov_b32 s37, 0x43000000
    v_fmac_f32 v10, s37, v12
    s_mov_b32 s37, 0x3c000000
    v_mul_f32 v12, s37, v90
    v_sub_f32 v12, v12, v11
    v_mul_f32 v12, v12, v12
    s_mov_b32 s37, 0x43000000
    v_fmac_f32 v10, s37, v12
    s_mov_b32 s37, 0x3c000000
    v_mul_f32 v12, s37, v92
    v_sub_f32 v12, v12, v11
    v_mul_f32 v12, v12, v12
    s_mov_b32 s37, 0x43000000
    v_fmac_f32 v10, s37, v12
    s_mov_b32 s37, 0x3c4f6475
    v_mul_f32 v12, s37, v94
    v_sub_f32 v12, v12, v11
    v_mul_f32 v12, v12, v12
    s_mov_b32 s37, 0x429e0000
    v_fmac_f32 v10, s37, v12
    v_mul_f32 v10, s36, v10
    v_add_f32 v10, 0x3727c5ac, v10
    v_rsq_f32 v10, v10
    s_nop 0
    v_mul_f32 v12, v10, v7
    v_mul_f32 v13, v11, v12
    v_sub_f32 v13, v8, v13
    v_lshlrev_b32 v5, 3, v0
    ds_write_b64 v5, v[12:13]
L_n_skip:
    s_mov_b64 exec, s[48:49]
    s_waitcnt lgkmcnt(0)
    s_barrier
    v_and_b32 v4, 7, v0
    v_lshlrev_b32 v4, 6, v4
    ds_read_b128 v[16:19], v4 offset:0
    ds_read_b128 v[20:23], v4 offset:16
    ds_read_b128 v[24:27], v4 offset:32
    ds_read_b128 v[28:31], v4 offset:48
    s_waitcnt vmcnt(0) lgkmcnt(0)
    s_mov_b32 s37, 0x3d372713
    s_mov_b32 s38, 0xc0135761
    v_lshlrev_b32 v48, 16, v32
    v_fma_f32 v48, v48, v16, v17
    v_mul_f32 v49, v48, v48
    v_fma_f32 v49, v49, s37, 1.0
    v_mul_f32 v49, v49, v48
    v_mul_f32 v49, s38, v49
    v_exp_f32 v49, v49
    s_nop 0
    v_add_f32 v49, 1.0, v49
    v_rcp_f32 v49, v49
    s_nop 0
    v_mul_f32 v50, v48, v49
    v_and_b32 v48, 0xffff0000, v32
    v_fma_f32 v48, v48, v18, v19
    v_mul_f32 v49, v48, v48
    v_fma_f32 v49, v49, s37, 1.0
    v_mul_f32 v49, v49, v48
    v_mul_f32 v49, s38, v49
    v_exp_f32 v49, v49
    s_nop 0
    v_add_f32 v49, 1.0, v49
    v_rcp_f32 v49, v49
    s_nop 0
    v_mul_f32 v51, v48, v49
    v_lshlrev_b32 v48, 16, v33
    v_fma_f32 v48, v48, v20, v21
    v_mul_f32 v49, v48, v48
    v_fma_f32 v49, v49, s37, 1.0
    v_mul_f32 v49, v49, v48
    v_mul_f32 v49, s38, v49
    v_exp_f32 v49, v49
    s_nop 0
    v_add_f32 v49, 1.0, v49
    v_rcp_f32 v49, v49
    s_nop 0
    v_mul_f32 v52, v48, v49
    v_and_b32 v48, 0xffff0000, v33
    v_fma_f32 v48, v48, v22, v23
    v_mul_f32 v49, v48, v48
    v_fma_f32 v49, v49, s37, 1.0
    v_mul_f32 v49, v49, v48
    v_mul_f32 v49, s38, v49
    v_exp_f32 v49, v49
    s_nop 0
    v_add_f32 v49, 1.0, v49
    v_rcp_f32 v49, v49
    s_nop 0
    v_mul_f32 v53, v48, v49
    v_lshlrev_b32 v48, 16, v34
    v_fma_f32 v48, v48, v24, v25
    v_mul_f32 v49, v48, v48
    v_fma_f32 v49, v49, s37, 1.0
    v_mul_f32 v49, v49, v48
    v_mul_f32 v49, s38, v49
    v_exp_f32 v49, v49
    s_nop 0
    v_add_f32 v49, 1.0, v49
    v_rcp_f32 v49, v49
    s_nop 0
    v_mul_f32 v54, v48, v49
    v_and_b32 v48, 0xffff0000, v34
    v_fma_f32 v48, v48, v26, v27
    v_mul_f32 v49, v48, v48
    v_fma_f32 v49, v49, s37, 1.0
    v_mul_f32 v49, v49, v48
    v_mul_f32 v49, s38, v49
    v_exp_f32 v49, v49
    s_nop 0
    v_add_f32 v49, 1.0, v49
    v_rcp_f32 v49, v49
    s_nop 0
    v_mul_f32 v55, v48, v49
    v_lshlrev_b32 v48, 16, v35
    v_fma_f32 v48, v48, v28, v29
    v_mul_f32 v49, v48, v48
    v_fma_f32 v49, v49, s37, 1.0
    v_mul_f32 v49, v49, v48
    v_mul_f32 v49, s38, v49
    v_exp_f32 v49, v49
    s_nop 0
    v_add_f32 v49, 1.0, v49
    v_rcp_f32 v49, v49
    s_nop 0
    v_mul_f32 v56, v48, v49
    v_and_b32 v48, 0xffff0000, v35
    v_fma_f32 v48, v48, v30, v31
    v_mul_f32 v49, v48, v48
    v_fma_f32 v49, v49, s37, 1.0
    v_mul_f32 v49, v49, v48
    v_mul_f32 v49, s38, v49
    v_exp_f32 v49, v49
    s_nop 0
    v_add_f32 v49, 1.0, v49
    v_rcp_f32 v49, v49
    s_nop 0
    v_mul_f32 v57, v48, v49
    v_cvt_pk_bf16_f32 v60, v50, v51
    v_cvt_pk_bf16_f32 v61, v52, v53
    v_cvt_pk_bf16_f32 v62, v54, v55
    v_cvt_pk_bf16_f32 v63, v56, v57
    v_add_u32 v5, 0, v2
    v_cmp_gt_u32 vcc, s43, v5
    s_and_saveexec_b64 s[48:49], vcc
    s_mov_b32 s36, 0
    buffer_store_dwordx4 v[60:63], v3, s[24:27], s36 offen
    s_mov_b64 exec, s[48:49]
    s_nop 1
    v_lshlrev_b32 v48, 16, v36
    v_fma_f32 v48, v48, v16, v17
    v_mul_f32 v49, v48, v48
    v_fma_f32 v49, v49, s37, 1.0
    v_mul_f32 v49, v49, v48
    v_mul_f32 v49, s38, v49
    v_exp_f32 v49, v49
    s_nop 0
    v_add_f32 v49, 1.0, v49
    v_rcp_f32 v49, v49
    s_nop 0
    v_mul_f32 v50, v48, v49
    v_and_b32 v48, 0xffff0000, v36
    v_fma_f32 v48, v48, v18, v19
    v_mul_f32 v49, v48, v48
    v_fma_f32 v49, v49, s37, 1.0
    v_mul_f32 v49, v49, v48
    v_mul_f32 v49, s38, v49
    v_exp_f32 v49, v49
    s_nop 0
    v_add_f32 v49, 1.0, v49
    v_rcp_f32 v49, v49
    s_nop 0
    v_mul_f32 v51, v48, v49
    v_lshlrev_b32 v48, 16, v37
    v_fma_f32 v48, v48, v20, v21
    v_mul_f32 v49, v48, v48
    v_fma_f32 v49, v49, s37, 1.0
    v_mul_f32 v49, v49, v48
    v_mul_f32 v49, s38, v49
    v_exp_f32 v49, v49
    s_nop 0
    v_add_f32 v49, 1.0, v49
    v_rcp_f32 v49, v49
    s_nop 0
    v_mul_f32 v52, v48, v49
    v_and_b32 v48, 0xffff0000, v37
    v_fma_f32 v48, v48, v22, v23
    v_mul_f32 v49, v48, v48
    v_fma_f32 v49, v49, s37, 1.0
    v_mul_f32 v49, v49, v48
    v_mul_f32 v49, s38, v49
    v_exp_f32 v49, v49
    s_nop 0
    v_add_f32 v49, 1.0, v49
    v_rcp_f32 v49, v49
    s_nop 0
    v_mul_f32 v53, v48, v49
    v_lshlrev_b32 v48, 16, v38
    v_fma_f32 v48, v48, v24, v25
    v_mul_f32 v49, v48, v48
    v_fma_f32 v49, v49, s37, 1.0
    v_mul_f32 v49, v49, v48
    v_mul_f32 v49, s38, v49
    v_exp_f32 v49, v49
    s_nop 0
    v_add_f32 v49, 1.0, v49
    v_rcp_f32 v49, v49
    s_nop 0
    v_mul_f32 v54, v48, v49
    v_and_b32 v48, 0xffff0000, v38
    v_fma_f32 v48, v48, v26, v27
    v_mul_f32 v49, v48, v48
    v_fma_f32 v49, v49, s37, 1.0
    v_mul_f32 v49, v49, v48
    v_mul_f32 v49, s38, v49
    v_exp_f32 v49, v49
    s_nop 0
    v_add_f32 v49, 1.0, v49
    v_rcp_f32 v49, v49
    s_nop 0
    v_mul_f32 v55, v48, v49
    v_lshlrev_b32 v48, 16, v39
    v_fma_f32 v48, v48, v28, v29
    v_mul_f32 v49, v48, v48
    v_fma_f32 v49, v49, s37, 1.0
    v_mul_f32 v49, v49, v48
    v_mul_f32 v49, s38, v49
    v_exp_f32 v49, v49
    s_nop 0
    v_add_f32 v49, 1.0, v49
    v_rcp_f32 v49, v49
    s_nop 0
    v_mul_f32 v56, v48, v49
    v_and_b32 v48, 0xffff0000, v39
    v_fma_f32 v48, v48, v30, v31
    v_mul_f32 v49, v48, v48
    v_fma_f32 v49, v49, s37, 1.0
    v_mul_f32 v49, v49, v48
    v_mul_f32 v49, s38, v49
    v_exp_f32 v49, v49
    s_nop 0
    v_add_f32 v49, 1.0, v49
    v_rcp_f32 v49, v49
    s_nop 0
    v_mul_f32 v57, v48, v49
    v_cvt_pk_bf16_f32 v60, v50, v51
    v_cvt_pk_bf16_f32 v61, v52, v53
    v_cvt_pk_bf16_f32 v62, v54, v55
    v_cvt_pk_bf16_f32 v63, v56, v57
    v_add_u32 v5, 32, v2
    v_cmp_gt_u32 vcc, s43, v5
    s_and_saveexec_b64 s[48:49], vcc
    s_mov_b32 s36, 32768
    buffer_store_dwordx4 v[60:63], v3, s[24:27], s36 offen
    s_mov_b64 exec, s[48:49]
    s_nop 1
    v_lshlrev_b32 v48, 16, v40
    v_fma_f32 v48, v48, v16, v17
    v_mul_f32 v49, v48, v48
    v_fma_f32 v49, v49, s37, 1.0
    v_mul_f32 v49, v49, v48
    v_mul_f32 v49, s38, v49
    v_exp_f32 v49, v49
    s_nop 0
    v_add_f32 v49, 1.0, v49
    v_rcp_f32 v49, v49
    s_nop 0
    v_mul_f32 v50, v48, v49
    v_and_b32 v48, 0xffff0000, v40
    v_fma_f32 v48, v48, v18, v19
    v_mul_f32 v49, v48, v48
    v_fma_f32 v49, v49, s37, 1.0
    v_mul_f32 v49, v49, v48
    v_mul_f32 v49, s38, v49
    v_exp_f32 v49, v49
    s_nop 0
    v_add_f32 v49, 1.0, v49
    v_rcp_f32 v49, v49
    s_nop 0
    v_mul_f32 v51, v48, v49
    v_lshlrev_b32 v48, 16, v41
    v_fma_f32 v48, v48, v20, v21
    v_mul_f32 v49, v48, v48
    v_fma_f32 v49, v49, s37, 1.0
    v_mul_f32 v49, v49, v48
    v_mul_f32 v49, s38, v49
    v_exp_f32 v49, v49
    s_nop 0
    v_add_f32 v49, 1.0, v49
    v_rcp_f32 v49, v49
    s_nop 0
    v_mul_f32 v52, v48, v49
    v_and_b32 v48, 0xffff0000, v41
    v_fma_f32 v48, v48, v22, v23
    v_mul_f32 v49, v48, v48
    v_fma_f32 v49, v49, s37, 1.0
    v_mul_f32 v49, v49, v48
    v_mul_f32 v49, s38, v49
    v_exp_f32 v49, v49
    s_nop 0
    v_add_f32 v49, 1.0, v49
    v_rcp_f32 v49, v49
    s_nop 0
    v_mul_f32 v53, v48, v49
    v_lshlrev_b32 v48, 16, v42
    v_fma_f32 v48, v48, v24, v25
    v_mul_f32 v49, v48, v48
    v_fma_f32 v49, v49, s37, 1.0
    v_mul_f32 v49, v49, v48
    v_mul_f32 v49, s38, v49
    v_exp_f32 v49, v49
    s_nop 0
    v_add_f32 v49, 1.0, v49
    v_rcp_f32 v49, v49
    s_nop 0
    v_mul_f32 v54, v48, v49
    v_and_b32 v48, 0xffff0000, v42
    v_fma_f32 v48, v48, v26, v27
    v_mul_f32 v49, v48, v48
    v_fma_f32 v49, v49, s37, 1.0
    v_mul_f32 v49, v49, v48
    v_mul_f32 v49, s38, v49
    v_exp_f32 v49, v49
    s_nop 0
    v_add_f32 v49, 1.0, v49
    v_rcp_f32 v49, v49
    s_nop 0
    v_mul_f32 v55, v48, v49
    v_lshlrev_b32 v48, 16, v43
    v_fma_f32 v48, v48, v28, v29
    v_mul_f32 v49, v48, v48
    v_fma_f32 v49, v49, s37, 1.0
    v_mul_f32 v49, v49, v48
    v_mul_f32 v49, s38, v49
    v_exp_f32 v49, v49
    s_nop 0
    v_add_f32 v49, 1.0, v49
    v_rcp_f32 v49, v49
    s_nop 0
    v_mul_f32 v56, v48, v49
    v_and_b32 v48, 0xffff0000, v43
    v_fma_f32 v48, v48, v30, v31
    v_mul_f32 v49, v48, v48
    v_fma_f32 v49, v49, s37, 1.0
    v_mul_f32 v49, v49, v48
    v_mul_f32 v49, s38, v49
    v_exp_f32 v49, v49
    s_nop 0
    v_add_f32 v49, 1.0, v49
    v_rcp_f32 v49, v49
    s_nop 0
    v_mul_f32 v57, v48, v49
    v_cvt_pk_bf16_f32 v60, v50, v51
    v_cvt_pk_bf16_f32 v61, v52, v53
    v_cvt_pk_bf16_f32 v62, v54, v55
    v_cvt_pk_bf16_f32 v63, v56, v57
    v_add_u32 v5, 64, v2
    v_cmp_gt_u32 vcc, s43, v5
    s_and_saveexec_b64 s[48:49], vcc
    s_mov_b32 s36, 65536
    buffer_store_dwordx4 v[60:63], v3, s[24:27], s36 offen
    s_mov_b64 exec, s[48:49]
    s_nop 1
    v_lshlrev_b32 v48, 16, v44
    v_fma_f32 v48, v48, v16, v17
    v_mul_f32 v49, v48, v48
    v_fma_f32 v49, v49, s37, 1.0
    v_mul_f32 v49, v49, v48
    v_mul_f32 v49, s38, v49
    v_exp_f32 v49, v49
    s_nop 0
    v_add_f32 v49, 1.0, v49
    v_rcp_f32 v49, v49
    s_nop 0
    v_mul_f32 v50, v48, v49
    v_and_b32 v48, 0xffff0000, v44
    v_fma_f32 v48, v48, v18, v19
    v_mul_f32 v49, v48, v48
    v_fma_f32 v49, v49, s37, 1.0
    v_mul_f32 v49, v49, v48
    v_mul_f32 v49, s38, v49
    v_exp_f32 v49, v49
    s_nop 0
    v_add_f32 v49, 1.0, v49
    v_rcp_f32 v49, v49
    s_nop 0
    v_mul_f32 v51, v48, v49
    v_lshlrev_b32 v48, 16, v45
    v_fma_f32 v48, v48, v20, v21
    v_mul_f32 v49, v48, v48
    v_fma_f32 v49, v49, s37, 1.0
    v_mul_f32 v49, v49, v48
    v_mul_f32 v49, s38, v49
    v_exp_f32 v49, v49
    s_nop 0
    v_add_f32 v49, 1.0, v49
    v_rcp_f32 v49, v49
    s_nop 0
    v_mul_f32 v52, v48, v49
    v_and_b32 v48, 0xffff0000, v45
    v_fma_f32 v48, v48, v22, v23
    v_mul_f32 v49, v48, v48
    v_fma_f32 v49, v49, s37, 1.0
    v_mul_f32 v49, v49, v48
    v_mul_f32 v49, s38, v49
    v_exp_f32 v49, v49
    s_nop 0
    v_add_f32 v49, 1.0, v49
    v_rcp_f32 v49, v49
    s_nop 0
    v_mul_f32 v53, v48, v49
    v_lshlrev_b32 v48, 16, v46
    v_fma_f32 v48, v48, v24, v25
    v_mul_f32 v49, v48, v48
    v_fma_f32 v49, v49, s37, 1.0
    v_mul_f32 v49, v49, v48
    v_mul_f32 v49, s38, v49
    v_exp_f32 v49, v49
    s_nop 0
    v_add_f32 v49, 1.0, v49
    v_rcp_f32 v49, v49
    s_nop 0
    v_mul_f32 v54, v48, v49
    v_and_b32 v48, 0xffff0000, v46
    v_fma_f32 v48, v48, v26, v27
    v_mul_f32 v49, v48, v48
    v_fma_f32 v49, v49, s37, 1.0
    v_mul_f32 v49, v49, v48
    v_mul_f32 v49, s38, v49
    v_exp_f32 v49, v49
    s_nop 0
    v_add_f32 v49, 1.0, v49
    v_rcp_f32 v49, v49
    s_nop 0
    v_mul_f32 v55, v48, v49
    v_lshlrev_b32 v48, 16, v47
    v_fma_f32 v48, v48, v28, v29
    v_mul_f32 v49, v48, v48
    v_fma_f32 v49, v49, s37, 1.0
    v_mul_f32 v49, v49, v48
    v_mul_f32 v49, s38, v49
    v_exp_f32 v49, v49
    s_nop 0
    v_add_f32 v49, 1.0, v49
    v_rcp_f32 v49, v49
    s_nop 0
    v_mul_f32 v56, v48, v49
    v_and_b32 v48, 0xffff0000, v47
    v_fma_f32 v48, v48, v30, v31
    v_mul_f32 v49, v48, v48
    v_fma_f32 v49, v49, s37, 1.0
    v_mul_f32 v49, v49, v48
    v_mul_f32 v49, s38, v49
    v_exp_f32 v49, v49
    s_nop 0
    v_add_f32 v49, 1.0, v49
    v_rcp_f32 v49, v49
    s_nop 0
    v_mul_f32 v57, v48, v49
    v_cvt_pk_bf16_f32 v60, v50, v51
    v_cvt_pk_bf16_f32 v61, v52, v53
    v_cvt_pk_bf16_f32 v62, v54, v55
    v_cvt_pk_bf16_f32 v63, v56, v57
    v_add_u32 v5, 96, v2
    v_cmp_gt_u32 vcc, s43, v5
    s_and_saveexec_b64 s[48:49], vcc
    s_mov_b32 s36, 98304
    buffer_store_dwordx4 v[60:63], v3, s[24:27], s36 offen
    s_mov_b64 exec, s[48:49]
    s_nop 1
L_n_done:
    s_endpgm
.section .rodata,"a"
.p2align 6
.amdhsa_kernel conv_gemm_kernel
  .amdhsa_next_free_vgpr 256
  .amdhsa_next_free_sgpr 102
  .amdhsa_accum_offset 256
  .amdhsa_group_segment_fixed_size 0
  .amdhsa_kernarg_size 64
  .amdhsa_user_sgpr_count 2
  .amdhsa_user_sgpr_kernarg_segment_ptr 1
  .amdhsa_system_sgpr_workgroup_id_x 1
.end_amdhsa_kernel
.p2align 6
.amdhsa_kernel norm_gelu_kernel
  .amdhsa_next_free_vgpr 128
  .amdhsa_next_free_sgpr 102
  .amdhsa_accum_offset 128
  .amdhsa_group_segment_fixed_size 0
  .amdhsa_kernarg_size 64
  .amdhsa_user_sgpr_count 2
  .amdhsa_user_sgpr_kernarg_segment_ptr 1
  .amdhsa_system_sgpr_workgroup_id_x 1
.end_amdhsa_kernel
```
